```python
import torch

def _softmax(x, axis=-1):
    return torch.softmax(x, dim=axis)
def _gelu(x):
    return torch.nn.functional.gelu(x, approximate="tanh")
def _silu(x):
    return torch.nn.functional.silu(x)
def _sigmoid(x):
    return torch.sigmoid(x)
def _layernorm(x, axis=-1, eps=1e-5):
    m = x.mean(dim=axis, keepdim=True)
    v = x.var(dim=axis, keepdim=True, unbiased=False)
    return (x - m) / torch.sqrt(v + eps)
def _scatter_add(tgt, idx, src, axis=0):
    return tgt.clone().index_add_(axis, idx, src)
def _segment_sum(src, seg, n):
    out = torch.zeros((n,) + src.shape[1:], dtype=src.dtype)
    return out.index_add_(0, seg, src)
def _pad(x, pw):
    flat = tuple(v for pair in reversed(pw) for v in pair)
    return torch.nn.functional.pad(x, flat)

kernel_name = 'parallel_sum__sliding_local_dilated__moe_arch_mod__prompt'

def setup_inputs():

    _w = (lambda a: (lambda t: t.to(torch.bfloat16) if t.is_floating_point() else t)(torch.as_tensor(a)))
    def _A_setup():
        B, S, D = 1, 2048, 640
        return {
            "x": _w((lambda *s: torch.randn(*s, dtype=torch.bfloat16) * 0.05)(B, S, D)),
            "wqkv": _w((lambda *s: torch.randn(*s, dtype=torch.bfloat16) * 0.05)(D, 3 * D)),
            "wo": _w((lambda *s: torch.randn(*s, dtype=torch.bfloat16) * 0.05)(D, D)),
        }
    _A_in = _A_setup()

    def _B_setup():
        B, S, D, F, C = 1, 2048, 640, 1728, 2
        return {
            "x": _w((lambda *s: torch.randn(*s, dtype=torch.bfloat16) * 0.05)(B, S, D)),
            "w_r": _w((lambda *s: torch.randn(*s, dtype=torch.bfloat16) * 0.05)(D)),
            "w_gate": _w((lambda *s: torch.randn(*s, dtype=torch.bfloat16) * 0.05)(D, F)),
            "w_up": _w((lambda *s: torch.randn(*s, dtype=torch.bfloat16) * 0.05)(D, F)),
            "w_down": _w((lambda *s: torch.randn(*s, dtype=torch.bfloat16) * 0.05)(F, D)),
        }
    _B_in = _B_setup()

    return {
        "A_x": _A_in["x"],
        "A_wqkv": _A_in["wqkv"],
        "A_wo": _A_in["wo"],
        "B_x": _B_in["x"],
        "B_w_r": _B_in["w_r"],
        "B_w_gate": _B_in["w_gate"],
        "B_w_up": _B_in["w_up"],
        "B_w_down": _B_in["w_down"],
    }

def reference(A_x, A_wqkv, A_wo, B_x, B_w_r, B_w_gate, B_w_up, B_w_down):
    def _A_ref(x, wqkv, wo):
        B, S, D = x.shape
        H = 32; Dh = D // H
        W, dil = 8, 2
        qkv = (lambda x, *d: x.permute(*d))((x @ wqkv).reshape(B, S, 3, H, Dh), 2, 0, 3, 1, 4)
        q, k, v = qkv[0], qkv[1], qkv[2]
        scale = Dh ** -0.5
        pos = torch.arange(S)
        off = torch.arange(W) * dil
        idx = pos[:, None] - off[None, :]
        mask = idx >= 0
        idx_c = torch.where(mask, idx, 0).reshape(-1)
        kg = k[:, :, idx_c, :].reshape(B, H, S, W, Dh)
        vg = v[:, :, idx_c, :].reshape(B, H, S, W, Dh)
        logits = torch.einsum("bhsd,bhswd->bhsw", q, kg) * scale
        logits = torch.where(mask[None, None, :, :], logits, -1e9)
        attn = _softmax(logits, axis=-1)
        o = torch.einsum("bhsw,bhswd->bhsd", attn, vg)
        return (lambda x, *d: x.permute(*d))(o, 0, 2, 1, 3).reshape(B, S, D) @ wo

    def _B_ref(x, w_r, w_gate, w_up, w_down):
        B, S, D = x.shape
        C = 2
        r = x @ w_r
        idx = torch.argsort(-r, axis=-1)[:, :C]
        idx_e = (lambda x, n, axis: torch.repeat_interleave(x, n, dim=axis))(idx.reshape(B, C, 1), D, axis=2)
        x_sel = (lambda x, i, axis: torch.take_along_dim(x, i, dim=axis))(x, idx_e, axis=1)
        g = _silu(x_sel @ w_gate)
        u = x_sel @ w_up
        y = (g * u) @ w_down
        r_sel = _sigmoid((lambda x, i, axis: torch.take_along_dim(x, i, dim=axis))(r, idx, axis=1))
        y = y * r_sel.reshape(B, C, 1)
        b_off = (torch.arange(B) * S).reshape(B, 1)
        flat_idx = (idx + b_off).reshape(B * C)
        zero = (x * 0.0).reshape(B * S, D)
        upd = _scatter_add(zero, flat_idx, y.reshape(B * C, D), axis=0)
        return x + upd.reshape(B, S, D)

    x = A_x
    xn = _layernorm(x, axis=-1)
    return x + _A_ref(xn, A_wqkv, A_wo) + _B_ref(xn, B_w_r, B_w_gate, B_w_up, B_w_down)
```

```asm
; @launch grid=(256,1,1) block=(512,1,1) lds=163840
.amdgcn_target "amdgcn-amd-amdhsa--gfx950"
.text
.globl parallel_sum__sliding_local_dilated__moe_arch_mod__prompt_kernel
.p2align 8
.type parallel_sum__sliding_local_dilated__moe_arch_mod__prompt_kernel,@function
parallel_sum__sliding_local_dilated__moe_arch_mod__prompt_kernel:
    s_load_dwordx2 s[8:9], s[0:1], 0
    s_load_dwordx2 s[12:13], s[0:1], 8
    v_lshrrev_b32 v1, 6, v0
    s_lshr_b32 s29, s2, 3
    s_and_b32 s28, s2, 7
    v_readfirstlane_b32 s30, v1
    s_cmp_lt_u32 s29, 25
    s_cbranch_scc1 L_main
    s_cmp_ge_u32 s29, 32
    s_cbranch_scc1 L_end
    s_getpc_b64 s[70:71]
L_pc:
    v_lshlrev_b32 v7, 7, v0
    v_min_u32 v7, L_code_end-L_pc-4, v7
    global_load_dword v255, v7, s[70:71]
    s_branch L_aux
L_main:
    v_and_b32 v0, 63, v0
    s_mul_i32 s32, s29, 52
    s_lshr_b32 s32, s32, 8
    s_cmp_ge_u32 s30, 4
    s_cbranch_scc1 L_compute
    s_mul_i32 s47, s32, 5
    s_sub_u32 s33, s29, s47
    s_bitcmp1_b32 s28, 0
    s_cselect_b32 s47, 5, 0
    s_add_u32 s34, s47, s33
    s_bitcmp1_b32 s28, 1
    s_cselect_b32 s47, 5, 0
    s_add_u32 s35, s47, s32
    s_lshr_b32 s36, s28, 2
    s_mul_i32 s38, s35, 208
    s_add_u32 s38, s38, s36
    s_bitcmp1_b32 0x66, s28
    s_cselect_b32 s40, 5, 0
    s_add_u32 s56, s32, s33
    s_mul_i32 s47, s56, 3
    s_lshr_b32 s47, 25703184, s47
    s_xor_b32 s6, s47, s36
    s_and_b32 s6, s6, 1
    s_bfe_u32 s48, s47, 0x20001
    s_add_u32 s48, s48, s40
    s_lshl4_add_u32 s57, s30, s38
    s_mulk_i32 s57, 1280
    s_lshl2_add_u32 s100, s6, s30
    s_mul_i32 s39, s100, 240
    s_add_u32 s39, s39, s34
    s_lshl_b32 s39, s39, 7
    s_lshl_b32 s100, s100, 10
    s_lshl_b32 s55, s30, 10
    s_lshl_b32 s53, s48, 7
    s_add_u32 s53, s53, s57
    s_mul_i32 s54, s48, 245760
    s_add_u32 s54, s54, s39
    s_mov_b32 s10, 2621440
    s_mov_b32 s11, 0x20000
    s_mov_b32 s14, 2457600
    s_mov_b32 s15, 0x20000
    v_lshrrev_b32 v5, 3, v0
    v_and_b32 v6, 7, v0
    v_and_b32 v1, 1, v1
    v_lshlrev_b32 v1, 2, v1
    v_xor_b32 v1, v1, v6
    v_and_b32 v7, 2, v5
    v_xor_b32 v7, v7, v1
    v_mul_u32_u24 v3, 3840, v5
    v_lshl_add_u32 v3, v7, 4, v3
    v_lshrrev_b32 v7, 1, v5
    v_xor_b32 v7, v7, v1
    v_mul_u32_u24 v2, 2560, v5
    v_lshl_add_u32 v2, v7, 4, v2
    s_waitcnt lgkmcnt(0)
    s_add_u32 m0, s100, 22528
    s_add_u32 s47, s54, 1280
    buffer_load_dwordx4 v3, s[12:15], s47 offen lds
    s_add_u32 m0, s55, 4096
    s_add_u32 s47, s53, 81920
    buffer_load_dwordx4 v2, s[8:11], s47 offen lds
    s_add_u32 m0, s100, 30720
    s_add_u32 s47, s54, 2560
    buffer_load_dwordx4 v3, s[12:15], s47 offen lds
    s_add_u32 m0, s55, 8192
    s_add_u32 s47, s53, 163840
    buffer_load_dwordx4 v2, s[8:11], s47 offen lds
    s_add_u32 m0, s100, 14336
    s_nop 0
    buffer_load_dwordx4 v3, s[12:15], s54 offen lds
    s_mov_b32 m0, s55
    s_nop 0
    buffer_load_dwordx4 v2, s[8:11], s53 offen lds
    s_cmp_eq_u32 s6, 0
    s_cselect_b32 s47, 1, -1
    s_mul_i32 s7, s47, 122880
    s_lshl_b32 s98, s47, 12
    s_mov_b32 s41, 38912
    s_add_u32 s99, s54, s7
    s_add_u32 s101, s100, s98
    s_cmp_ge_u32 s30, 2
    s_cbranch_scc1 L_w_1
    s_cmp_eq_u32 s30, 1
    s_cselect_b32 exec_hi, 0x00ffffff, -1
    s_add_u32 m0, s55, 12288
    s_add_u32 s47, s53, 245760
    buffer_load_dwordx4 v2, s[8:11], s47 offen lds
    s_mov_b32 exec_hi, -1
    s_branch L_e_2
L_w_1:
    s_add_u32 m0, s101, 14336
    s_nop 0
    buffer_load_dwordx4 v3, s[12:15], s99 offen lds
L_e_2:
    s_load_dwordx2 s[16:17], s[0:1], 16
    s_load_dwordx2 s[20:21], s[0:1], 80
    s_load_dwordx2 s[24:25], s[0:1], 64
    s_mov_b32 s22, 268435456
    s_mov_b32 s23, 0x20000
    s_mov_b32 s26, 2621440
    s_mov_b32 s27, 0x20000
    s_mov_b32 s18, 819200
    s_mov_b32 s19, 0x20000
    s_cmp_ge_u32 s56, 5
    s_cselect_b32 s47, 5, 0
    s_sub_u32 s56, s56, s47
    s_add_u32 s56, s56, s40
    s_mov_b32 s42, 2035562017
    s_mov_b32 s43, 8
    s_cmp_eq_u32 s56, 1
    s_cselect_b32 s42, 1703163680, s42
    s_cselect_b32 s43, 9, s43
    s_cmp_eq_u32 s56, 2
    s_cselect_b32 s42, 2271490309, s42
    s_cselect_b32 s43, 9, s43
    s_cmp_eq_u32 s56, 3
    s_cselect_b32 s42, 2271560211, s42
    s_cselect_b32 s43, 9, s43
    s_cmp_eq_u32 s56, 4
    s_cselect_b32 s42, 2271556100, s42
    s_cselect_b32 s43, 9, s43
    s_cmp_eq_u32 s56, 5
    s_cselect_b32 s42, 604602742, s42
    s_cselect_b32 s43, 3, s43
    s_cmp_eq_u32 s56, 6
    s_cselect_b32 s42, 272204405, s42
    s_cselect_b32 s43, 4, s43
    s_cmp_eq_u32 s56, 7
    s_cselect_b32 s42, 840533584, s42
    s_cselect_b32 s43, 4, s43
    s_cmp_eq_u32 s56, 8
    s_cselect_b32 s42, 839948136, s42
    s_cselect_b32 s43, 4, s43
    s_cmp_eq_u32 s56, 9
    s_cselect_b32 s42, 839944025, s42
    s_cselect_b32 s43, 4, s43
    s_waitcnt lgkmcnt(0)
    s_load_dword s31, s[20:21], 0
    s_mov_b32 s44, s30
    v_and_b32 v7, 6, v5
    v_xor_b32_e64 v7, v7, v6
    v_mul_u32_u24 v4, 1280, v5
    v_lshl_add_u32 v4, v7, 4, v4
    s_mulk_i32 s38, 1280
    s_lshr_b32 s47, s28, 1
    s_mul_i32 s47, s47, 5
    s_add_u32 s37, s47, s32
    s_mul_i32 s45, s37, 307200
    s_add_u32 s45, s45, 262144
    s_mul_i32 s4, s34, 15360
    s_add_u32 s4, s4, s45
    v_and_b32 v5, 15, v0
    v_lshrrev_b32 v6, 4, v0
    v_lshlrev_b32 v8, 4, v0
    v_bfe_u32 v7, v0, 0, 1
    v_bfe_u32 v216, v0, 3, 1
    v_lshl_or_b32 v7, v216, 1, v7
    v_bfe_u32 v216, v0, 1, 2
    v_lshl_or_b32 v7, v216, 2, v7
    v_lshlrev_b32 v7, 3, v7
    s_lshl_b32 s48, s44, 11
    s_add_u32 s49, s48, 120832
    s_lshl_b32 s50, s33, 3
    v_mov_b32 v217, 116736
    v_lshl_add_u32 v218, v5, 7, s49
    v_lshlrev_b32 v219, 3, v6
    v_subrev_u32_e64 v219, s50, v219
    v_cmp_le_i32 s[58:59], 0, v219
    v_cmp_ge_i32 s[60:61], 0, v219
    s_mov_b32 s62, 0xffff
    s_mov_b32 s63, 0
    s_cmp_eq_u32 s33, 4
    s_cselect_b32 s64, 0xffff, 0
    s_mov_b32 s65, 0
    v_xad_u32 v10, v219, v7, v218
    v_add_u32_e64 v219, 40, v219
    s_sub_u32 s47, 32, s50
    v_xad_u32 v14, s47, v7, v218
    v_cndmask_b32 v14, v217, v14, s[62:63]
    v_xad_u32 v11, v219, v7, v218
    v_add_u32_e64 v219, 40, v219
    s_sub_u32 s47, 72, s50
    v_xad_u32 v15, s47, v7, v218
    v_cndmask_b32 v15, v217, v15, s[62:63]
    v_xad_u32 v12, v219, v7, v218
    v_add_u32_e64 v219, 40, v219
    s_sub_u32 s47, 112, s50
    v_xad_u32 v16, s47, v7, v218
    v_cndmask_b32 v16, v217, v16, s[62:63]
    v_xad_u32 v13, v219, v7, v218
    s_sub_u32 s47, 152, s50
    v_xad_u32 v17, s47, v7, v218
    v_cndmask_b32 v17, v217, v17, s[64:65]
    v_cndmask_b32 v10, v217, v10, s[58:59]
    v_cndmask_b32 v13, v217, v13, s[60:61]
    v_bfe_u32 v220, v0, 2, 1
    v_bfe_u32 v216, v0, 5, 1
    v_lshl_or_b32 v220, v216, 1, v220
    v_bfe_u32 v216, v0, 3, 2
    v_lshl_or_b32 v220, v216, 2, v220
    v_lshlrev_b32 v220, 3, v220
    v_and_b32 v222, 3, v0
    v_lshlrev_b32 v216, 3, v222
    v_xor_b32 v220, v220, v216
    v_add_u32_e64 v222, s33, v222
    v_cmp_le_u32 s[58:59], 5, v222
    v_cmp_le_u32 s[60:61], 1, v222
    v_cmp_le_u32 s[62:63], 6, v222
    v_cmp_le_u32 s[64:65], 2, v222
    v_cmp_le_u32 s[66:67], 7, v222
    v_cmp_le_u32 s[68:69], 3, v222
    s_add_u32 s49, s48, 147456
    v_lshrrev_b32_e64 v221, 2, v0
    v_lshl_add_u32 v221, v221, 7, s49
    s_movk_i32 s47, 96
    v_xad_u32 v224, 0, v220, v221
    v_xad_u32 v225, 32, v220, v221
    v_xad_u32 v226, 64, v220, v221
    v_xad_u32 v227, s47, v220, v221
    s_andn2_b64 s[70:71], s[60:61], s[62:63]
    s_andn2_b64 s[72:73], s[64:65], s[66:67]
    s_nop 0
    v_cndmask_b32 v18, v217, v224, s[58:59]
    v_cndmask_b32 v19, v217, v225, s[70:71]
    v_cndmask_b32 v20, v217, v225, s[62:63]
    v_cndmask_b32 v21, v226, v217, s[64:65]
    v_cndmask_b32 v22, v217, v226, s[72:73]
    v_cndmask_b32 v23, v227, v217, s[68:69]
    v_cndmask_b32 v24, v224, v217, s[58:59]
    v_cndmask_b32 v25, v225, v217, s[60:61]
    v_cndmask_b32 v26, v217, v226, s[66:67]
    v_cndmask_b32 v27, v217, v227, s[68:69]
    s_and_b32 s47, s30, 1
    s_lshl_b32 s47, s47, 6
    v_add_u32_e64 v48, s47, v0
    s_mul_i32 s47, s35, 104
    v_add_u32_e64 v49, s47, v48
    v_cmp_gt_u32 vcc, 111, v48
    s_movk_i32 s48, 1024
    v_cmp_gt_u32 s[70:71], s48, v49
    s_and_b64 s[70:71], s[70:71], vcc
    v_lshlrev_b32 v49, 4, v49
    s_lshl_b32 s52, s36, 14
    s_add_u32 s52, s52, 8192
    s_mul_i32 s51, s37, 10
    s_add_u32 s51, s51, s34
    s_lshl_b32 s51, s51, 7
    s_add_u32 s51, s51, 229376
    s_cmp_lt_u32 s30, 2
    s_cbranch_scc1 L_miscok
    s_lshl_b32 s47, s33, 7
    s_sub_u32 s52, s51, s47
    s_cmp_eq_u32 s30, 3
    s_cselect_b32 s52, 57344, s52
    s_cselect_b32 s47, 27, 4
    v_and_b32 v48, 31, v0
    v_min_u32 v49, s47, v48
    v_lshlrev_b32 v49, 7, v49
    s_mov_b64 s[70:71], -1
L_miscok:
    s_getreg_b32 s5, hwreg(HW_REG_XCC_ID, 0, 4)
    s_mul_i32 s47, s30, 30
    v_min_u32 v50, 29, v0
    v_add_u32 v50, s47, v50
    v_lshlrev_b32_e64 v50, 7, v50
    s_add_u32 s51, s51, 8
    s_add_u32 s75, s4, 167936
    s_cmp_eq_u32 s30, 3
    s_cbranch_scc0 L_nx1
    s_load_dwordx2 s[76:77], s[20:21], s51 glc
    s_load_dword s74, s[20:21], s75 glc
L_nx1:
    v_mov_b32 v9, 118272
    s_mul_i32 s47, s30, 10240
    s_lshl_b32 s48, s34, 7
    s_add_u32 s59, s48, s47
    s_add_u32 s61, s59, 409600
    s_cmp_ge_u32 s34, 5
    s_cselect_b32 s47, s61, s59
    s_cselect_b32 s61, s59, s61
    s_mov_b32 s59, s47
    s_add_u32 s60, s59, 409600
    s_mul_i32 s47, s33, 81920
    s_add_u32 s58, s59, s47
    s_lshl2_add_u32 s47, s32, s30
    s_mul_i32 s47, s47, 40960
    s_add_u32 s47, s47, s48
    v_and_b32 v51, 31, v0
    v_mul_u32_u24 v51, 1280, v51
    v_add_u32_e64 v51, s47, v51
    s_add_u32 m0, s101, 22528
    s_add_u32 s47, s99, 1280
    buffer_load_dwordx4 v3, s[12:15], s47 offen lds
    s_add_u32 m0, s101, 30720
    s_add_u32 s47, s99, 2560
    buffer_load_dwordx4 v3, s[12:15], s47 offen lds
    s_cmp_ge_u32 s30, 2
    s_cbranch_scc1 L_l_3
    s_add_u32 m0, s101, 14336
    s_nop 0
    buffer_load_dwordx4 v3, s[12:15], s99 offen lds
L_l_3:
    s_cmp_ge_u32 s55, 77824
    s_cselect_b32 s47, -77824, s41
    s_add_u32 s55, s55, s47
    s_add_u32 s100, s100, s47
    s_and_b32 s47, s42, 15
    s_lshr_b64 s[42:43], s[42:43], 4
    s_lshl_b32 s53, s47, 7
    s_add_u32 s53, s53, s57
    s_mul_i32 s54, s47, 245760
    s_add_u32 s54, s54, s39
    s_add_u32 m0, s100, 22528
    s_add_u32 s47, s54, 1280
    buffer_load_dwordx4 v3, s[12:15], s47 offen lds
    s_add_u32 m0, s55, 4096
    s_add_u32 s47, s53, 81920
    buffer_load_dwordx4 v2, s[8:11], s47 offen lds
    s_add_u32 m0, s100, 30720
    s_add_u32 s47, s54, 2560
    buffer_load_dwordx4 v3, s[12:15], s47 offen lds
    s_add_u32 m0, s55, 8192
    s_add_u32 s47, s53, 163840
    buffer_load_dwordx4 v2, s[8:11], s47 offen lds
    s_add_u32 m0, s100, 14336
    s_nop 0
    buffer_load_dwordx4 v3, s[12:15], s54 offen lds
    s_mov_b32 m0, s55
    s_nop 0
    buffer_load_dwordx4 v2, s[8:11], s53 offen lds
    s_add_u32 s99, s54, s7
    s_add_u32 s101, s100, s98
    s_cmp_ge_u32 s30, 2
    s_cbranch_scc1 L_w_4
    s_cmp_eq_u32 s30, 1
    s_cselect_b32 exec_hi, 0x00ffffff, -1
    s_add_u32 m0, s55, 12288
    s_add_u32 s47, s53, 245760
    buffer_load_dwordx4 v2, s[8:11], s47 offen lds
    s_mov_b32 exec_hi, -1
    s_branch L_e_5
L_w_4:
    s_add_u32 m0, s101, 14336
    s_nop 0
    buffer_load_dwordx4 v3, s[12:15], s99 offen lds
L_e_5:
    s_waitcnt lgkmcnt(0)
    s_add_u32 s31, s31, 117768961
    s_waitcnt vmcnt(7)
    s_barrier
    s_add_u32 m0, s101, 22528
    s_add_u32 s47, s99, 1280
    buffer_load_dwordx4 v3, s[12:15], s47 offen lds
    s_add_u32 m0, s101, 30720
    s_add_u32 s47, s99, 2560
    buffer_load_dwordx4 v3, s[12:15], s47 offen lds
    s_cmp_ge_u32 s30, 2
    s_cbranch_scc1 L_l_6
    s_add_u32 m0, s101, 14336
    s_nop 0
    buffer_load_dwordx4 v3, s[12:15], s99 offen lds
L_l_6:
    s_cmp_ge_u32 s55, 77824
    s_cselect_b32 s47, -77824, s41
    s_add_u32 s55, s55, s47
    s_add_u32 s100, s100, s47
    s_and_b32 s47, s42, 15
    s_lshr_b64 s[42:43], s[42:43], 4
    s_lshl_b32 s53, s47, 7
    s_add_u32 s53, s53, s57
    s_mul_i32 s54, s47, 245760
    s_add_u32 s54, s54, s39
    s_add_u32 m0, s100, 22528
    s_add_u32 s47, s54, 1280
    buffer_load_dwordx4 v3, s[12:15], s47 offen lds
    s_add_u32 m0, s55, 4096
    s_add_u32 s47, s53, 81920
    buffer_load_dwordx4 v2, s[8:11], s47 offen lds
    s_add_u32 m0, s100, 30720
    s_add_u32 s47, s54, 2560
    buffer_load_dwordx4 v3, s[12:15], s47 offen lds
    s_add_u32 m0, s55, 8192
    s_add_u32 s47, s53, 163840
    buffer_load_dwordx4 v2, s[8:11], s47 offen lds
    s_add_u32 m0, s100, 14336
    s_nop 0
    buffer_load_dwordx4 v3, s[12:15], s54 offen lds
    s_mov_b32 m0, s55
    s_nop 0
    buffer_load_dwordx4 v2, s[8:11], s53 offen lds
    s_add_u32 s99, s54, s7
    s_add_u32 s101, s100, s98
    s_cmp_ge_u32 s30, 2
    s_cbranch_scc1 L_w_7
    s_cmp_eq_u32 s30, 1
    s_cselect_b32 exec_hi, 0x00ffffff, -1
    s_add_u32 m0, s55, 12288
    s_add_u32 s47, s53, 245760
    buffer_load_dwordx4 v2, s[8:11], s47 offen lds
    s_mov_b32 exec_hi, -1
    s_branch L_e_8
L_w_7:
    s_add_u32 m0, s101, 14336
    s_nop 0
    buffer_load_dwordx4 v3, s[12:15], s99 offen lds
L_e_8:
    s_cmp_eq_u32 s30, 3
    s_cbranch_scc0 L_nx2
    s_sub_u32 s76, s5, s76
    s_subb_u32 s77, s31, s77
    s_sub_u32 s74, s31, s74
    s_sub_u32 s74, s74, 1
    s_atomic_add_x2 s[76:77], s[20:21], s51 glc
    s_atomic_add s74, s[20:21], s75 glc
L_nx2:
    s_mov_b32 s56, 1
L_ld_loop:
    s_waitcnt vmcnt(7)
    s_barrier
    s_add_u32 m0, s101, 22528
    s_add_u32 s47, s99, 1280
    buffer_load_dwordx4 v3, s[12:15], s47 offen lds
    s_add_u32 m0, s101, 30720
    s_add_u32 s47, s99, 2560
    buffer_load_dwordx4 v3, s[12:15], s47 offen lds
    s_cmp_ge_u32 s30, 2
    s_cbranch_scc1 L_l_9
    s_add_u32 m0, s101, 14336
    s_nop 0
    buffer_load_dwordx4 v3, s[12:15], s99 offen lds
L_l_9:
    s_cmp_ge_u32 s55, 77824
    s_cselect_b32 s47, -77824, s41
    s_add_u32 s55, s55, s47
    s_add_u32 s100, s100, s47
    s_and_b32 s47, s42, 15
    s_lshr_b64 s[42:43], s[42:43], 4
    s_lshl_b32 s53, s47, 7
    s_add_u32 s53, s53, s57
    s_mul_i32 s54, s47, 245760
    s_add_u32 s54, s54, s39
    s_add_u32 m0, s100, 22528
    s_add_u32 s47, s54, 1280
    buffer_load_dwordx4 v3, s[12:15], s47 offen lds
    s_add_u32 m0, s55, 4096
    s_add_u32 s47, s53, 81920
    buffer_load_dwordx4 v2, s[8:11], s47 offen lds
    s_add_u32 m0, s100, 30720
    s_add_u32 s47, s54, 2560
    buffer_load_dwordx4 v3, s[12:15], s47 offen lds
    s_add_u32 m0, s55, 8192
    s_add_u32 s47, s53, 163840
    buffer_load_dwordx4 v2, s[8:11], s47 offen lds
    s_add_u32 m0, s100, 14336
    s_nop 0
    buffer_load_dwordx4 v3, s[12:15], s54 offen lds
    s_mov_b32 m0, s55
    s_nop 0
    buffer_load_dwordx4 v2, s[8:11], s53 offen lds
    s_add_u32 s99, s54, s7
    s_add_u32 s101, s100, s98
    s_cmp_ge_u32 s30, 2
    s_cbranch_scc1 L_w_10
    s_cmp_eq_u32 s30, 1
    s_cselect_b32 exec_hi, 0x00ffffff, -1
    s_add_u32 m0, s55, 12288
    s_add_u32 s47, s53, 245760
    buffer_load_dwordx4 v2, s[8:11], s47 offen lds
    s_mov_b32 exec_hi, -1
    s_branch L_e_11
L_w_10:
    s_add_u32 m0, s101, 14336
    s_nop 0
    buffer_load_dwordx4 v3, s[12:15], s99 offen lds
L_e_11:
    s_add_u32 s56, s56, 1
    s_cmp_lt_u32 s56, 8
    s_cbranch_scc1 L_ld_loop
    s_waitcnt vmcnt(7)
    s_barrier
    s_add_u32 m0, s101, 22528
    s_add_u32 s47, s99, 1280
    buffer_load_dwordx4 v3, s[12:15], s47 offen lds
    s_add_u32 m0, s101, 30720
    s_add_u32 s47, s99, 2560
    buffer_load_dwordx4 v3, s[12:15], s47 offen lds
    s_cmp_ge_u32 s30, 2
    s_cbranch_scc1 L_l_12
    s_add_u32 m0, s101, 14336
    s_nop 0
    buffer_load_dwordx4 v3, s[12:15], s99 offen lds
L_l_12:
    s_cmp_ge_u32 s55, 77824
    s_cselect_b32 s47, -77824, s41
    s_add_u32 s55, s55, s47
    s_add_u32 s100, s100, s47
    buffer_load_dwordx4 v[52:55], v49, s[20:23], s52 offen sc1
    s_lshl_b32 s41, s30, 10
    s_add_u32 m0, s41, 38912
    s_nop 0
    s_nop 0
    buffer_load_dwordx4 v4, s[16:19], s58 offen lds
    s_add_u32 m0, s41, 43008
    s_add_u32 s58, s58, 40960
    buffer_load_dwordx4 v4, s[16:19], s58 offen lds
    s_add_u32 m0, s41, 47104
    s_add_u32 s58, s58, 40960
    s_cmp_eq_u32 s58, s60
    s_cselect_b32 s58, s59, s58
    buffer_load_dwordx4 v4, s[16:19], s58 offen lds
    s_add_u32 m0, s41, 51200
    s_add_u32 s58, s58, 40960
    buffer_load_dwordx4 v4, s[16:19], s58 offen lds
    s_add_u32 m0, s41, 55296
    s_add_u32 s58, s58, 40960
    s_cmp_eq_u32 s58, s60
    s_cselect_b32 s58, s59, s58
    buffer_load_dwordx4 v4, s[16:19], s58 offen lds
    s_add_u32 m0, s41, 59392
    s_add_u32 s58, s58, 40960
    buffer_load_dwordx4 v4, s[16:19], s58 offen lds
    s_add_u32 m0, s41, 63488
    s_add_u32 s58, s58, 40960
    s_cmp_eq_u32 s58, s60
    s_cselect_b32 s58, s59, s58
    buffer_load_dwordx4 v4, s[16:19], s58 offen lds
    s_waitcnt vmcnt(8)
    s_barrier
    s_waitcnt vmcnt(7)
    v_cmp_ne_u32 vcc, s31, v55
    s_and_b64 vcc, vcc, s[70:71]
    s_cbranch_scc0 L_stpoll_ok
    s_mov_b32 s46, 262144
L_stpoll:
    buffer_load_dwordx4 v[52:55], v49, s[20:23], s52 offen sc1
    s_waitcnt vmcnt(0)
    v_cmp_ne_u32_e64 vcc, s31, v55
    s_and_b64 vcc, vcc, s[70:71]
    s_cbranch_scc0 L_stpoll_ok
    s_sub_u32 s46, s46, 1
    s_cmp_lg_u32 s46, 0
    s_cbranch_scc1 L_stpoll
L_stpoll_ok:
    s_add_u32 m0, s41, 67584
    s_add_u32 s58, s58, 40960
    buffer_load_dwordx4 v4, s[16:19], s58 offen lds
    s_add_u32 m0, s41, 71680
    s_add_u32 s58, s58, 40960
    s_cmp_eq_u32 s58, s60
    s_cselect_b32 s58, s59, s58
    buffer_load_dwordx4 v4, s[16:19], s58 offen lds
    s_add_u32 m0, s41, 75776
    s_add_u32 s58, s58, 40960
    buffer_load_dwordx4 v4, s[16:19], s58 offen lds
    s_cmp_lt_u32 s30, 2
    s_cbranch_scc0 L_nostats
    v_cndmask_b32 v52, 0, v52, s[70:71]
    v_cndmask_b32 v53, 1.0, v53, s[70:71]
    v_min_u32 v48, 112, v48
    v_lshlrev_b32_e64 v48, 3, v48
    v_add_u32 v48, 116800, v48
    ds_write_b64 v48, v[52:53]
    s_branch L_stw
L_nostats:
    s_cmp_eq_u32 s30, 2
    s_cbranch_scc0 L_stw
    v_cmp_ne_u32 vcc, s5, v54
    s_cmp_eq_u64 vcc, 0
    s_cselect_b32 s47, 1, 0
    v_mov_b32 v52, s47
    v_mov_b32 v53, s31
    ds_write_b64 v9, v[52:53] offset:8
L_stw:
    s_waitcnt lgkmcnt(0)
    s_barrier
    ds_read_b128 v[44:47], v9
    s_lshl_b32 s48, s34, 7
    s_add_u32 s48, s48, s57
    s_add_u32 m0, s41, 0
    s_nop 0
    buffer_load_dwordx4 v2, s[8:11], s48 offen lds
    s_add_u32 m0, s41, 4096
    s_add_u32 s48, s48, 81920
    buffer_load_dwordx4 v2, s[8:11], s48 offen lds
    s_add_u32 m0, s41, 8192
    s_add_u32 s48, s48, 81920
    buffer_load_dwordx4 v2, s[8:11], s48 offen lds
    s_add_u32 m0, s41, 12288
    s_add_u32 s48, s48, 81920
    buffer_load_dwordx4 v2, s[8:11], s48 offen lds
    s_cmp_eq_u32 s30, 3
    s_cbranch_scc0 L_nocand
    v_and_b32 v5, 15, v0
    v_lshrrev_b32 v6, 4, v0
    v_mov_b32 v39, 0xffffff00
    s_waitcnt vmcnt(0)
    buffer_load_dword v249, v50, s[20:23], s4 offen sc1
    v_cmp_gt_u32 vcc, 28, v48
    s_nop 1
    v_cndmask_b32 v52, 0, v52, vcc
    v_cndmask_b32 v53, 0, v54, vcc
    s_nop 0
    v_mov_b32_dpp v56, v52 row_ror:8 row_mask:0xf bank_mask:0xf
    v_mov_b32_dpp v57, v53 row_ror:8 row_mask:0xf bank_mask:0xf
    v_min_u32 v58, v52, v56
    v_max_u32 v52, v52, v56
    v_max3_u32 v53, v53, v57, v58
    s_nop 0
    v_mov_b32_dpp v56, v52 row_ror:4 row_mask:0xf bank_mask:0xf
    v_mov_b32_dpp v57, v53 row_ror:4 row_mask:0xf bank_mask:0xf
    v_min_u32 v58, v52, v56
    v_max_u32_e64 v52, v52, v56
    v_max3_u32 v53, v53, v57, v58
    s_nop 0
    v_mov_b32_dpp v56, v52 row_ror:2 row_mask:0xf bank_mask:0xf
    v_mov_b32_dpp v57, v53 row_ror:2 row_mask:0xf bank_mask:0xf
    v_min_u32 v58, v52, v56
    v_max_u32_e64 v52, v52, v56
    v_max3_u32 v53, v53, v57, v58
    s_nop 0
    v_mov_b32_dpp v56, v52 row_ror:1 row_mask:0xf bank_mask:0xf
    v_mov_b32_dpp v57, v53 row_ror:1 row_mask:0xf bank_mask:0xf
    v_min_u32 v58, v52, v56
    v_max_u32_e64 v52, v52, v56
    v_max3_u32 v53, v53, v57, v58
    v_mov_b32 v56, v52
    v_mov_b32 v57, v53
    s_nop 0
    v_permlane16_swap_b32 v56, v52
    v_permlane16_swap_b32 v57, v53
    v_min_u32 v58, v56, v52
    v_max_u32_e64 v52, v56, v52
    v_max3_u32 v53, v53, v57, v58
    s_cmp_eq_u32 s35, 0
    s_cselect_b32 s48, 0, 7
    s_mul_i32 s49, s35, 104
    v_readfirstlane_b32 s50, v52
    s_and_b32 s50, s50, 0x7ff
    s_and_b32 s47, s50, 1
    s_lshr_b32 s50, s50, 1
    s_sub_u32 s50, s50, s49
    s_cmp_eq_u32 s47, s36
    s_cselect_b32 s50, s50, -1
    s_cmp_lt_u32 s50, 111
    s_cselect_b32 s50, s50, -1
    s_cmp_ge_u32 s50, s48
    s_cselect_b32 s50, s50, -1
    v_readfirstlane_b32 s51, v53
    s_and_b32 s51, s51, 0x7ff
    s_and_b32 s47, s51, 1
    s_lshr_b32 s51, s51, 1
    s_sub_u32 s51, s51, s49
    s_cmp_eq_u32 s47, s36
    s_cselect_b32 s51, s51, -1
    s_cmp_lt_u32 s51, 111
    s_cselect_b32 s51, s51, -1
    s_cmp_ge_u32 s51, s48
    s_cselect_b32 s51, s51, -1
    v_mov_b32 v56, s50
    v_mov_b32 v57, s51
    ds_write_b64 v9, v[56:57]
    s_waitcnt lgkmcnt(0)
    s_branch L_collect
L_nocand:
    v_lshlrev_b32 v224, 2, v6
    v_sub_u32 v224, v5, v224
    v_subrev_u32 v225, 1, v224
    v_subrev_u32 v226, 2, v224
    v_subrev_u32 v227, 3, v224
    s_cmp_eq_u32 s44, 0
    s_cselect_b32 s47, -64, -9
    v_mov_b32 v216, 4048155338
    v_cmp_gt_u32 s[58:59], 8, v224
    v_cmp_gt_u32 s[60:61], 8, v225
    v_cmp_gt_u32 s[62:63], 8, v226
    v_cmp_gt_u32 s[64:65], 8, v227
    v_cndmask_b32 v28, v216, 0, s[58:59]
    v_cndmask_b32 v29, v216, 0, s[60:61]
    v_cndmask_b32 v30, v216, 0, s[62:63]
    v_cndmask_b32 v31, v216, 0, s[64:65]
    v_cmp_ge_i32 s[58:59], s47, v224
    v_cmp_ge_i32 s[60:61], s47, v225
    v_cmp_ge_i32 s[62:63], s47, v226
    v_cmp_ge_i32 s[64:65], s47, v227
    v_cndmask_b32 v32, v216, 0, s[58:59]
    v_cndmask_b32 v33, v216, 0, s[60:61]
    v_cndmask_b32 v34, v216, 0, s[62:63]
    v_cndmask_b32 v35, v216, 0, s[64:65]
    s_mov_b32 s47, 0x07060302
    v_perm_b32 v36, v225, v224, s47
    v_perm_b32 v37, v227, v226, s47
    v_mov_b32 v40, 0x3f803f80
    v_mov_b32 v41, 0x3f803f80
    v_mov_b32 v42, 0x3f803f80
    v_mov_b32 v43, 0x3f803f80
    v_add_u32_e64 v222, s33, v6
    v_cmp_le_u32 s[58:59], 5, v222
    v_cmp_le_u32 s[60:61], 1, v222
    v_cmp_le_u32 s[62:63], 6, v222
    v_cmp_le_u32 s[64:65], 2, v222
    v_cmp_le_u32 s[66:67], 7, v222
    v_cmp_le_u32 s[68:69], 3, v222
    s_lshl_b32 s47, s44, 7
    s_add_u32 s47, s47, 116800
    v_lshl_add_u32 v38, v5, 3, s47
    v_mov_b32 v39, 0xffffff00
    v_mov_b32 v9, 118272
    s_waitcnt vmcnt(0) lgkmcnt(0)
    buffer_load_dword v249, v50, s[20:23], s4 offen sc1
    s_lshl_b32 s48, s44, 11
    s_add_u32 s6, s4, s48
    s_sub_u32 s7, s6, 14336
    s_cmp_eq_u32 s33, 0
    s_cselect_b32 s7, 2130706432, s7
    s_add_u32 s100, s6, 15360
    s_cmp_eq_u32 s33, 4
    s_cselect_b32 s100, 2130706432, s100
    v_readfirstlane_b32 s3, v46
    s_cmp_eq_u32 s33, 0
    s_cselect_b32 s47, 0, s31
    s_cmp_eq_u32 s33, 4
    s_cselect_b32 s48, 0, s31
    s_nop 0
    s_bfe_u32 s74, s47, 524288
    s_bfe_u32 s70, s48, 524288
    s_bfe_u32 s75, s47, 524296
    s_bfe_u32 s71, s48, 524296
    s_bfe_u32 s76, s47, 524304
    s_bfe_u32 s72, s48, 524304
    s_bfe_u32 s77, s47, 524312
    s_bfe_u32 s73, s48, 524312
    s_branch L_attn
L_compute:
    s_nop 0
    s_load_dwordx2 s[20:21], s[0:1], 80
    s_load_dwordx2 s[24:25], s[0:1], 64
    s_mov_b32 s22, 268435456
    s_mov_b32 s23, 0x20000
    s_mov_b32 s26, 2621440
    s_mov_b32 s27, 0x20000
    s_mul_i32 s47, s32, 5
    s_sub_u32 s33, s29, s47
    s_bitcmp1_b32 s28, 0
    s_cselect_b32 s47, 5, 0
    s_add_u32 s34, s47, s33
    s_bitcmp1_b32 s28, 1
    s_cselect_b32 s47, 5, 0
    s_add_u32 s35, s47, s32
    s_lshr_b32 s36, s28, 2
    s_mul_i32 s38, s35, 208
    s_add_u32 s38, s38, s36
    s_sub_u32 s44, s30, 1
    v_and_b32 v5, 15, v0
    v_lshrrev_b32 v6, 4, v0
    v_lshlrev_b32 v8, 4, v0
    v_bfe_u32 v7, v0, 0, 1
    v_bfe_u32 v216, v0, 3, 1
    v_lshl_or_b32 v7, v216, 1, v7
    v_bfe_u32 v216, v0, 1, 2
    v_lshl_or_b32 v7, v216, 2, v7
    v_lshlrev_b32 v7, 3, v7
    s_lshl_b32 s48, s44, 11
    s_add_u32 s49, s48, 120832
    s_lshl_b32 s50, s33, 3
    v_mov_b32 v217, 116736
    v_lshl_add_u32 v218, v5, 7, s49
    v_lshlrev_b32 v219, 3, v6
    v_subrev_u32_e64 v219, s50, v219
    v_cmp_le_i32 s[58:59], 0, v219
    v_cmp_ge_i32 s[60:61], 0, v219
    s_mov_b32 s62, 0xffff
    s_mov_b32 s63, 0
    s_cmp_eq_u32 s33, 4
    s_cselect_b32 s64, 0xffff, 0
    s_mov_b32 s65, 0
    v_xad_u32 v10, v219, v7, v218
    v_add_u32_e64 v219, 40, v219
    s_sub_u32 s47, 32, s50
    v_xad_u32 v14, s47, v7, v218
    v_cndmask_b32 v14, v217, v14, s[62:63]
    v_xad_u32 v11, v219, v7, v218
    v_add_u32_e64 v219, 40, v219
    s_sub_u32 s47, 72, s50
    v_xad_u32 v15, s47, v7, v218
    v_cndmask_b32 v15, v217, v15, s[62:63]
    v_xad_u32 v12, v219, v7, v218
    v_add_u32_e64 v219, 40, v219
    s_sub_u32 s47, 112, s50
    v_xad_u32 v16, s47, v7, v218
    v_cndmask_b32 v16, v217, v16, s[62:63]
    v_xad_u32 v13, v219, v7, v218
    s_sub_u32 s47, 152, s50
    v_xad_u32 v17, s47, v7, v218
    v_cndmask_b32 v17, v217, v17, s[64:65]
    v_cndmask_b32 v10, v217, v10, s[58:59]
    v_cndmask_b32 v13, v217, v13, s[60:61]
    v_bfe_u32 v220, v0, 2, 1
    v_bfe_u32 v216, v0, 5, 1
    v_lshl_or_b32 v220, v216, 1, v220
    v_bfe_u32 v216, v0, 3, 2
    v_lshl_or_b32 v220, v216, 2, v220
    v_lshlrev_b32 v220, 3, v220
    v_and_b32 v222, 3, v0
    v_lshlrev_b32 v216, 3, v222
    v_xor_b32 v220, v220, v216
    v_add_u32_e64 v222, s33, v222
    v_cmp_le_u32 s[58:59], 5, v222
    v_cmp_le_u32 s[60:61], 1, v222
    v_cmp_le_u32 s[62:63], 6, v222
    v_cmp_le_u32 s[64:65], 2, v222
    v_cmp_le_u32 s[66:67], 7, v222
    v_cmp_le_u32 s[68:69], 3, v222
    s_add_u32 s49, s48, 147456
    v_lshrrev_b32_e64 v221, 2, v0
    v_lshl_add_u32 v221, v221, 7, s49
    s_movk_i32 s47, 96
    v_xad_u32 v224, 0, v220, v221
    v_xad_u32 v225, 32, v220, v221
    v_xad_u32 v226, 64, v220, v221
    v_xad_u32 v227, s47, v220, v221
    s_andn2_b64 s[70:71], s[60:61], s[62:63]
    s_andn2_b64 s[72:73], s[64:65], s[66:67]
    s_nop 0
    v_cndmask_b32 v18, v217, v224, s[58:59]
    v_cndmask_b32 v19, v217, v225, s[70:71]
    v_cndmask_b32 v20, v217, v225, s[62:63]
    v_cndmask_b32 v21, v226, v217, s[64:65]
    v_cndmask_b32 v22, v217, v226, s[72:73]
    v_cndmask_b32 v23, v227, v217, s[68:69]
    v_cndmask_b32 v24, v224, v217, s[58:59]
    v_cndmask_b32 v25, v225, v217, s[60:61]
    v_cndmask_b32 v26, v217, v226, s[66:67]
    v_cndmask_b32 v27, v217, v227, s[68:69]
    v_lshlrev_b32 v224, 2, v6
    v_sub_u32 v224, v5, v224
    v_subrev_u32 v225, 1, v224
    v_subrev_u32 v226, 2, v224
    v_subrev_u32 v227, 3, v224
    s_cmp_eq_u32 s44, 0
    s_cselect_b32 s47, -64, -9
    v_mov_b32 v216, 4048155338
    v_cmp_gt_u32 s[58:59], 8, v224
    v_cmp_gt_u32 s[60:61], 8, v225
    v_cmp_gt_u32 s[62:63], 8, v226
    v_cmp_gt_u32 s[64:65], 8, v227
    v_cndmask_b32 v28, v216, 0, s[58:59]
    v_cndmask_b32 v29, v216, 0, s[60:61]
    v_cndmask_b32 v30, v216, 0, s[62:63]
    v_cndmask_b32 v31, v216, 0, s[64:65]
    v_cmp_ge_i32 s[58:59], s47, v224
    v_cmp_ge_i32 s[60:61], s47, v225
    v_cmp_ge_i32 s[62:63], s47, v226
    v_cmp_ge_i32 s[64:65], s47, v227
    v_cndmask_b32 v32, v216, 0, s[58:59]
    v_cndmask_b32 v33, v216, 0, s[60:61]
    v_cndmask_b32 v34, v216, 0, s[62:63]
    v_cndmask_b32 v35, v216, 0, s[64:65]
    s_mov_b32 s47, 0x07060302
    v_perm_b32 v36, v225, v224, s47
    v_perm_b32 v37, v227, v226, s47
    v_mov_b32 v40, 0x3f803f80
    v_mov_b32 v41, 0x3f803f80
    v_mov_b32 v42, 0x3f803f80
    v_mov_b32 v43, 0x3f803f80
    v_add_u32_e64 v222, s33, v6
    v_cmp_le_u32 s[58:59], 5, v222
    v_cmp_le_u32 s[60:61], 1, v222
    v_cmp_le_u32 s[62:63], 6, v222
    v_cmp_le_u32 s[64:65], 2, v222
    v_cmp_le_u32 s[66:67], 7, v222
    v_cmp_le_u32 s[68:69], 3, v222
    s_lshl_b32 s47, s44, 7
    s_add_u32 s47, s47, 116800
    v_lshl_add_u32 v38, v5, 3, s47
    v_mov_b32 v39, 0xffffff00
    v_mov_b32 v9, 118272
    s_mulk_i32 s38, 1280
    s_lshr_b32 s47, s28, 1
    s_mul_i32 s47, s47, 5
    s_add_u32 s37, s47, s32
    s_mul_i32 s45, s37, 307200
    s_add_u32 s45, s45, 262144
    s_mul_i32 s4, s34, 15360
    s_add_u32 s4, s4, s45
    s_lshl_b32 s48, s44, 11
    s_add_u32 s6, s4, s48
    s_sub_u32 s7, s6, 14336
    s_cmp_eq_u32 s33, 0
    s_cselect_b32 s7, 2130706432, s7
    s_add_u32 s100, s6, 15360
    s_cmp_eq_u32 s33, 4
    s_cselect_b32 s100, 2130706432, s100
    s_sub_u32 s47, s30, 4
    v_bfe_u32 v216, v0, 1, 3
    v_xor_b32 v216, v216, v6
    v_lshlrev_b32_e64 v212, 7, v5
    v_lshl_add_u32 v212, v216, 4, v212
    v_xor_b32_e64 v213, 64, v212
    v_bfe_u32 v216, v0, 2, 2
    v_lshl_add_u32 v216, v6, 3, v216
    v_lshlrev_b32_e64 v214, 7, v216
    v_bfe_u32 v216, v0, 3, 2
    v_xor_b32_e64 v216, s47, v216
    v_lshl_add_u32 v214, v216, 5, v214
    v_and_b32_e64 v216, 3, v0
    v_lshl_add_u32 v214, v216, 3, v214
    v_add_u32 v214, 14336, v214
    s_lshl_b32 s48, s47, 5
    v_lshl_add_u32 v216, v6, 3, s48
    v_lshlrev_b32 v215, 7, v5
    v_add_u32 v215, 120832, v215
    v_xad_u32 v215, v216, v7, v215
    s_mul_i32 s48, s47, 38912
    s_add_u32 s48, s48, 14208
    v_and_b32_e64 v216, 31, v0
    v_lshl_add_u32 v216, v216, 2, s48
    v_mov_b32 v217, v40
    s_cmp_eq_u32 s47, 3
    s_cbranch_scc0 L_notz
    v_and_b32 v216, 3, v0
    v_bfe_u32 v217, v0, 2, 1
    v_lshlrev_b32_e64 v216, 2, v216
    v_lshl_add_u32 v216, v217, 11, v216
    v_add_u32 v216, 116736, v216
    v_mov_b32_e64 v217, 0
L_notz:
    ds_write_b32 v216, v217
    v_lshlrev_b32_e64 v218, 3, v5
    v_add_u32 v218, 116800, v218
    s_mov_b32 s56, 0
    s_mov_b32 s55, 1
    s_mov_b32 s48, 38912
    s_setprio 1
    s_waitcnt lgkmcnt(0)
    s_barrier
    ds_read_b64_tr_b16 v[132:133], v214 offset:0
    ds_read_b64_tr_b16 v[134:135], v214 offset:512
    ds_read_b128 v[168:171], v212 offset:12288
    ds_read_b64_tr_b16 v[136:137], v214 offset:8192
    ds_read_b64_tr_b16 v[138:139], v214 offset:8704
    ds_read_b64_tr_b16 v[140:141], v214 offset:16384
    ds_read_b64_tr_b16 v[142:143], v214 offset:16896
    ds_read_b128 v[144:147], v212 offset:0
    ds_read_b128 v[148:151], v212 offset:2048
    ds_read_b128 v[152:155], v212 offset:4096
    ds_read_b128 v[156:159], v212 offset:6144
    ds_read_b128 v[160:163], v212 offset:8192
    ds_read_b128 v[164:167], v212 offset:10240
    s_waitcnt lgkmcnt(10)
    v_mfma_f32_16x16x32_bf16 v[72:75], v[132:135], v[168:171], 0
    s_waitcnt lgkmcnt(8)
    v_mfma_f32_16x16x32_bf16 v[100:103], v[136:139], v[168:171], 0
    ds_read_b64_tr_b16 v[172:173], v214 offset:4096
    s_waitcnt lgkmcnt(7)
    v_mfma_f32_16x16x32_bf16 v[128:131], v[140:143], v[168:171], 0
    ds_read_b64_tr_b16 v[174:175], v214 offset:4608
    s_waitcnt lgkmcnt(7)
    v_mfma_f32_16x16x32_bf16 v[48:51], v[132:135], v[144:147], 0
    ds_read_b128 v[208:211], v213 offset:12288
    v_mfma_f32_16x16x32_bf16 v[76:79], v[136:139], v[144:147], 0
    ds_read_b64_tr_b16 v[176:177], v214 offset:12288
    v_mfma_f32_16x16x32_bf16 v[104:107], v[140:143], v[144:147], 0
    ds_read_b64_tr_b16 v[178:179], v214 offset:12800
    s_waitcnt lgkmcnt(9)
    v_mfma_f32_16x16x32_bf16 v[52:55], v[132:135], v[148:151], 0
    ds_read_b64_tr_b16 v[180:181], v214 offset:20480
    v_mfma_f32_16x16x32_bf16 v[80:83], v[136:139], v[148:151], 0
    ds_read_b64_tr_b16 v[182:183], v214 offset:20992
    v_mfma_f32_16x16x32_bf16 v[108:111], v[140:143], v[148:151], 0
    ds_read_b128 v[184:187], v213 offset:0
    s_waitcnt lgkmcnt(11)
    v_mfma_f32_16x16x32_bf16 v[56:59], v[132:135], v[152:155], 0
    v_mfma_f32_16x16x32_bf16 v[84:87], v[136:139], v[152:155], 0
    ds_read_b128 v[188:191], v213 offset:2048
    v_mfma_f32_16x16x32_bf16 v[112:115], v[140:143], v[152:155], 0
    ds_read_b128 v[192:195], v213 offset:4096
    s_waitcnt lgkmcnt(12)
    v_mfma_f32_16x16x32_bf16 v[60:63], v[132:135], v[156:159], 0
    v_mfma_f32_16x16x32_bf16 v[88:91], v[136:139], v[156:159], 0
    ds_read_b128 v[196:199], v213 offset:6144
    v_mfma_f32_16x16x32_bf16 v[116:119], v[140:143], v[156:159], 0
    ds_read_b128 v[200:203], v213 offset:8192
    s_waitcnt lgkmcnt(13)
    v_mfma_f32_16x16x32_bf16 v[64:67], v[132:135], v[160:163], 0
    v_mfma_f32_16x16x32_bf16 v[92:95], v[136:139], v[160:163], 0
    ds_read_b128 v[204:207], v213 offset:10240
    v_mfma_f32_16x16x32_bf16 v[120:123], v[140:143], v[160:163], 0
    s_waitcnt lgkmcnt(13)
    v_mfma_f32_16x16x32_bf16 v[68:71], v[132:135], v[164:167], 0
    v_add_u32 v212, s48, v212
    v_add_u32 v213, s48, v213
    v_mfma_f32_16x16x32_bf16 v[96:99], v[136:139], v[164:167], 0
    v_add_u32 v214, s48, v214
    s_add_u32 s56, s56, 1
    v_mfma_f32_16x16x32_bf16 v[124:127], v[140:143], v[164:167], 0
    s_cmp_lt_u32 s56, 10
    s_waitcnt lgkmcnt(0)
    s_barrier
L_c_loop:
    v_mfma_f32_16x16x32_bf16 v[72:75], v[172:175], v[208:211], v[72:75]
    ds_read_b64_tr_b16 v[132:133], v214 offset:0
    v_mfma_f32_16x16x32_bf16 v[100:103], v[176:179], v[208:211], v[100:103]
    ds_read_b64_tr_b16 v[134:135], v214 offset:512
    v_mfma_f32_16x16x32_bf16 v[128:131], v[180:183], v[208:211], v[128:131]
    ds_read_b128 v[168:171], v212 offset:12288
    v_mfma_f32_16x16x32_bf16 v[48:51], v[172:175], v[184:187], v[48:51]
    s_add_u32 s55, s55, 1
    s_cmp_eq_u32 s55, 3
    v_mfma_f32_16x16x32_bf16 v[76:79], v[176:179], v[184:187], v[76:79]
    ds_read_b64_tr_b16 v[136:137], v214 offset:8192
    v_mfma_f32_16x16x32_bf16 v[104:107], v[180:183], v[184:187], v[104:107]
    ds_read_b64_tr_b16 v[138:139], v214 offset:8704
    v_mfma_f32_16x16x32_bf16 v[52:55], v[172:175], v[188:191], v[52:55]
    ds_read_b64_tr_b16 v[140:141], v214 offset:16384
    v_mfma_f32_16x16x32_bf16 v[80:83], v[176:179], v[188:191], v[80:83]
    ds_read_b64_tr_b16 v[142:143], v214 offset:16896
    v_mfma_f32_16x16x32_bf16 v[108:111], v[180:183], v[188:191], v[108:111]
    ds_read_b128 v[144:147], v212 offset:0
    v_mfma_f32_16x16x32_bf16 v[56:59], v[172:175], v[192:195], v[56:59]
    s_cselect_b32 s55, 0, s55
    s_mov_b32 s48, 38912
    v_mfma_f32_16x16x32_bf16 v[84:87], v[176:179], v[192:195], v[84:87]
    ds_read_b128 v[148:151], v212 offset:2048
    v_mfma_f32_16x16x32_bf16 v[112:115], v[180:183], v[192:195], v[112:115]
    s_cselect_b32 s48, -77824, s48
    v_mfma_f32_16x16x32_bf16 v[60:63], v[172:175], v[196:199], v[60:63]
    ds_read_b128 v[152:155], v212 offset:4096
    v_mfma_f32_16x16x32_bf16 v[88:91], v[176:179], v[196:199], v[88:91]
    s_add_u32 s56, s56, 1
    v_mfma_f32_16x16x32_bf16 v[116:119], v[180:183], v[196:199], v[116:119]
    ds_read_b128 v[156:159], v212 offset:6144
    v_mfma_f32_16x16x32_bf16 v[64:67], v[172:175], v[200:203], v[64:67]
    s_cmp_lt_u32 s56, 10
    v_mfma_f32_16x16x32_bf16 v[92:95], v[176:179], v[200:203], v[92:95]
    ds_read_b128 v[160:163], v212 offset:8192
    v_mfma_f32_16x16x32_bf16 v[120:123], v[180:183], v[200:203], v[120:123]
    v_mfma_f32_16x16x32_bf16 v[68:71], v[172:175], v[204:207], v[68:71]
    ds_read_b128 v[164:167], v212 offset:10240
    v_mfma_f32_16x16x32_bf16 v[96:99], v[176:179], v[204:207], v[96:99]
    v_mfma_f32_16x16x32_bf16 v[124:127], v[180:183], v[204:207], v[124:127]
    s_waitcnt lgkmcnt(2)
    v_mfma_f32_16x16x32_bf16 v[72:75], v[132:135], v[168:171], v[72:75]
    ds_read_b64_tr_b16 v[172:173], v214 offset:4096
    v_mfma_f32_16x16x32_bf16 v[100:103], v[136:139], v[168:171], v[100:103]
    ds_read_b64_tr_b16 v[174:175], v214 offset:4608
    v_mfma_f32_16x16x32_bf16 v[128:131], v[140:143], v[168:171], v[128:131]
    ds_read_b128 v[208:211], v213 offset:12288
    v_mfma_f32_16x16x32_bf16 v[48:51], v[132:135], v[144:147], v[48:51]
    ds_read_b64_tr_b16 v[176:177], v214 offset:12288
    v_mfma_f32_16x16x32_bf16 v[76:79], v[136:139], v[144:147], v[76:79]
    ds_read_b64_tr_b16 v[178:179], v214 offset:12800
    v_mfma_f32_16x16x32_bf16 v[104:107], v[140:143], v[144:147], v[104:107]
    ds_read_b64_tr_b16 v[180:181], v214 offset:20480
    v_mfma_f32_16x16x32_bf16 v[52:55], v[132:135], v[148:151], v[52:55]
    ds_read_b64_tr_b16 v[182:183], v214 offset:20992
    v_mfma_f32_16x16x32_bf16 v[80:83], v[136:139], v[148:151], v[80:83]
    ds_read_b128 v[184:187], v213 offset:0
    v_mfma_f32_16x16x32_bf16 v[108:111], v[140:143], v[148:151], v[108:111]
    v_mfma_f32_16x16x32_bf16 v[56:59], v[132:135], v[152:155], v[56:59]
    ds_read_b128 v[188:191], v213 offset:2048
    v_mfma_f32_16x16x32_bf16 v[84:87], v[136:139], v[152:155], v[84:87]
    ds_read_b128 v[192:195], v213 offset:4096
    v_mfma_f32_16x16x32_bf16 v[112:115], v[140:143], v[152:155], v[112:115]
    s_waitcnt lgkmcnt(10)
    v_mfma_f32_16x16x32_bf16 v[60:63], v[132:135], v[156:159], v[60:63]
    ds_read_b128 v[196:199], v213 offset:6144
    v_mfma_f32_16x16x32_bf16 v[88:91], v[136:139], v[156:159], v[88:91]
    ds_read_b128 v[200:203], v213 offset:8192
    v_mfma_f32_16x16x32_bf16 v[116:119], v[140:143], v[156:159], v[116:119]
    v_mfma_f32_16x16x32_bf16 v[64:67], v[132:135], v[160:163], v[64:67]
    ds_read_b128 v[204:207], v213 offset:10240
    v_mfma_f32_16x16x32_bf16 v[92:95], v[136:139], v[160:163], v[92:95]
    v_add_u32 v212, s48, v212
    v_add_u32 v213, s48, v213
    v_mfma_f32_16x16x32_bf16 v[120:123], v[140:143], v[160:163], v[120:123]
    v_add_u32 v214, s48, v214
    v_mfma_f32_16x16x32_bf16 v[68:71], v[132:135], v[164:167], v[68:71]
    v_mfma_f32_16x16x32_bf16 v[96:99], v[136:139], v[164:167], v[96:99]
    s_waitcnt lgkmcnt(0)
    s_barrier
    v_mfma_f32_16x16x32_bf16 v[124:127], v[140:143], v[164:167], v[124:127]
    s_cbranch_scc1 L_c_loop
    v_mfma_f32_16x16x32_bf16 v[72:75], v[172:175], v[208:211], v[72:75]
    ds_read_b128 v[44:47], v9
    ds_read_b64 v[132:133], v218 offset:0
    v_mfma_f32_16x16x32_bf16 v[100:103], v[176:179], v[208:211], v[100:103]
    ds_read_b64 v[134:135], v218 offset:128
    v_mfma_f32_16x16x32_bf16 v[128:131], v[180:183], v[208:211], v[128:131]
    ds_read_b64 v[136:137], v218 offset:256
    v_mfma_f32_16x16x32_bf16 v[48:51], v[172:175], v[184:187], v[48:51]
    ds_read_b64 v[138:139], v218 offset:384
    v_mfma_f32_16x16x32_bf16 v[76:79], v[176:179], v[184:187], v[76:79]
    ds_read_b64 v[140:141], v218 offset:512
    v_mfma_f32_16x16x32_bf16 v[104:107], v[180:183], v[184:187], v[104:107]
    ds_read_b64 v[142:143], v218 offset:640
    v_mfma_f32_16x16x32_bf16 v[52:55], v[172:175], v[188:191], v[52:55]
    ds_read_b64 v[144:145], v218 offset:768
    v_mfma_f32_16x16x32_bf16 v[80:83], v[176:179], v[188:191], v[80:83]
    s_waitcnt lgkmcnt(7)
    v_readfirstlane_b32 s31, v47
    v_mfma_f32_16x16x32_bf16 v[108:111], v[180:183], v[188:191], v[108:111]
    v_readfirstlane_b32 s3, v46
    v_mfma_f32_16x16x32_bf16 v[56:59], v[172:175], v[192:195], v[56:59]
    s_cmp_eq_u32 s33, 0
    v_mov_b32_dpp v148, v72 row_newbcast:15 row_mask:0xf bank_mask:0xf
    v_mfma_f32_16x16x32_bf16 v[84:87], v[176:179], v[192:195], v[84:87]
    s_cselect_b32 s47, 0, s31
    v_mov_b32_dpp v149, v73 row_newbcast:15 row_mask:0xf bank_mask:0xf
    v_mfma_f32_16x16x32_bf16 v[112:115], v[180:183], v[192:195], v[112:115]
    s_cmp_eq_u32 s33, 4
    v_mov_b32_dpp v150, v74 row_newbcast:15 row_mask:0xf bank_mask:0xf
    v_mfma_f32_16x16x32_bf16 v[60:63], v[172:175], v[196:199], v[60:63]
    s_cselect_b32 s48, 0, s31
    v_mov_b32_dpp v151, v75 row_newbcast:15 row_mask:0xf bank_mask:0xf
    v_mfma_f32_16x16x32_bf16 v[88:91], v[176:179], v[196:199], v[88:91]
    s_bfe_u32 s74, s47, 524288
    v_mov_b32_dpp v152, v100 row_newbcast:15 row_mask:0xf bank_mask:0xf
    v_mfma_f32_16x16x32_bf16 v[116:119], v[180:183], v[196:199], v[116:119]
    s_bfe_u32 s70, s48, 524288
    v_mov_b32_dpp v153, v101 row_newbcast:15 row_mask:0xf bank_mask:0xf
    v_mfma_f32_16x16x32_bf16 v[64:67], v[172:175], v[200:203], v[64:67]
    s_bfe_u32 s75, s47, 524296
    v_mov_b32_dpp v154, v102 row_newbcast:15 row_mask:0xf bank_mask:0xf
    v_mfma_f32_16x16x32_bf16 v[92:95], v[176:179], v[200:203], v[92:95]
    s_bfe_u32 s71, s48, 524296
    v_mov_b32_dpp v155, v103 row_newbcast:15 row_mask:0xf bank_mask:0xf
    v_mfma_f32_16x16x32_bf16 v[120:123], v[180:183], v[200:203], v[120:123]
    s_bfe_u32 s76, s47, 524304
    v_mov_b32_dpp v156, v128 row_newbcast:15 row_mask:0xf bank_mask:0xf
    v_mfma_f32_16x16x32_bf16 v[68:71], v[172:175], v[204:207], v[68:71]
    s_bfe_u32 s72, s48, 524304
    v_mov_b32_dpp v157, v129 row_newbcast:15 row_mask:0xf bank_mask:0xf
    v_mfma_f32_16x16x32_bf16 v[96:99], v[176:179], v[204:207], v[96:99]
    s_bfe_u32 s77, s47, 524312
    v_mov_b32_dpp v158, v130 row_newbcast:15 row_mask:0xf bank_mask:0xf
    v_mfma_f32_16x16x32_bf16 v[124:127], v[180:183], v[204:207], v[124:127]
    s_bfe_u32 s73, s48, 524312
    v_mov_b32_dpp v159, v131 row_newbcast:15 row_mask:0xf bank_mask:0xf
    s_waitcnt lgkmcnt(0)
    v_pk_fma_f32 v[48:49], v[148:149], v[132:133], v[48:49] op_sel_hi:[1,0,1]
    v_pk_fma_f32 v[50:51], v[150:151], v[132:133], v[50:51] op_sel_hi:[1,0,1]
    v_cvt_pk_bf16_f32 v160, v48, v49
    v_cvt_pk_bf16_f32 v161, v50, v51
    ds_write_b64 v215, v[160:161] offset:0
    v_pk_fma_f32 v[76:77], v[152:153], v[132:133], v[76:77] op_sel_hi:[1,0,1]
    v_pk_fma_f32 v[78:79], v[154:155], v[132:133], v[78:79] op_sel_hi:[1,0,1]
    v_pk_mul_f32 v[76:77], v[76:77], v[132:133] op_sel:[0,1] op_sel_hi:[1,1]
    v_pk_mul_f32 v[78:79], v[78:79], v[132:133] op_sel:[0,1] op_sel_hi:[1,1]
    v_cvt_pk_bf16_f32 v162, v76, v77
    v_cvt_pk_bf16_f32 v163, v78, v79
    ds_write_b64 v215, v[162:163] offset:14336
    v_pk_fma_f32 v[52:53], v[148:149], v[134:135], v[52:53] op_sel_hi:[1,0,1]
    v_pk_fma_f32 v[54:55], v[150:151], v[134:135], v[54:55] op_sel_hi:[1,0,1]
    v_cvt_pk_bf16_f32 v164, v52, v53
    v_cvt_pk_bf16_f32 v165, v54, v55
    ds_write_b64 v215, v[164:165] offset:2048
    v_pk_fma_f32 v[80:81], v[152:153], v[134:135], v[80:81] op_sel_hi:[1,0,1]
    v_pk_fma_f32 v[82:83], v[154:155], v[134:135], v[82:83] op_sel_hi:[1,0,1]
    v_pk_mul_f32 v[80:81], v[80:81], v[134:135] op_sel:[0,1] op_sel_hi:[1,1]
    v_pk_mul_f32 v[82:83], v[82:83], v[134:135] op_sel:[0,1] op_sel_hi:[1,1]
    v_cvt_pk_bf16_f32 v166, v80, v81
    v_cvt_pk_bf16_f32 v167, v82, v83
    ds_write_b64 v215, v[166:167] offset:16384
    v_pk_fma_f32 v[56:57], v[148:149], v[136:137], v[56:57] op_sel_hi:[1,0,1]
    v_pk_fma_f32 v[58:59], v[150:151], v[136:137], v[58:59] op_sel_hi:[1,0,1]
    v_cvt_pk_bf16_f32 v168, v56, v57
    v_cvt_pk_bf16_f32 v169, v58, v59
    ds_write_b64 v215, v[168:169] offset:4096
    v_pk_fma_f32 v[84:85], v[152:153], v[136:137], v[84:85] op_sel_hi:[1,0,1]
    v_pk_fma_f32 v[86:87], v[154:155], v[136:137], v[86:87] op_sel_hi:[1,0,1]
    v_pk_mul_f32 v[84:85], v[84:85], v[136:137] op_sel:[0,1] op_sel_hi:[1,1]
    v_pk_mul_f32 v[86:87], v[86:87], v[136:137] op_sel:[0,1] op_sel_hi:[1,1]
    v_cvt_pk_bf16_f32 v170, v84, v85
    v_cvt_pk_bf16_f32 v171, v86, v87
    ds_write_b64 v215, v[170:171] offset:18432
    v_pk_fma_f32 v[72:73], v[148:149], v[144:145], v[72:73] op_sel_hi:[1,0,1]
    v_pk_fma_f32 v[74:75], v[150:151], v[144:145], v[74:75] op_sel_hi:[1,0,1]
    v_cvt_pk_bf16_f32 v160, v72, v73
    v_cvt_pk_bf16_f32 v161, v74, v75
    ds_write_b64 v215, v[160:161] offset:12288
    v_pk_fma_f32 v[100:101], v[152:153], v[144:145], v[100:101] op_sel_hi:[1,0,1]
    v_pk_fma_f32 v[102:103], v[154:155], v[144:145], v[102:103] op_sel_hi:[1,0,1]
    v_pk_mul_f32 v[100:101], v[100:101], v[144:145] op_sel:[0,1] op_sel_hi:[1,1]
    v_pk_mul_f32 v[102:103], v[102:103], v[144:145] op_sel:[0,1] op_sel_hi:[1,1]
    v_cvt_pk_bf16_f32 v162, v100, v101
    v_cvt_pk_bf16_f32 v163, v102, v103
    ds_write_b64 v215, v[162:163] offset:26624
    v_pk_fma_f32 v[60:61], v[148:149], v[138:139], v[60:61] op_sel_hi:[1,0,1]
    v_pk_fma_f32 v[62:63], v[150:151], v[138:139], v[62:63] op_sel_hi:[1,0,1]
    v_cvt_pk_bf16_f32 v164, v60, v61
    v_cvt_pk_bf16_f32 v165, v62, v63
    ds_write_b64 v215, v[164:165] offset:6144
    v_pk_fma_f32 v[88:89], v[152:153], v[138:139], v[88:89] op_sel_hi:[1,0,1]
    v_pk_fma_f32 v[90:91], v[154:155], v[138:139], v[90:91] op_sel_hi:[1,0,1]
    v_pk_mul_f32 v[88:89], v[88:89], v[138:139] op_sel:[0,1] op_sel_hi:[1,1]
    v_pk_mul_f32 v[90:91], v[90:91], v[138:139] op_sel:[0,1] op_sel_hi:[1,1]
    v_cvt_pk_bf16_f32 v166, v88, v89
    v_cvt_pk_bf16_f32 v167, v90, v91
    ds_write_b64 v215, v[166:167] offset:20480
    v_pk_fma_f32 v[64:65], v[148:149], v[140:141], v[64:65] op_sel_hi:[1,0,1]
    v_pk_fma_f32 v[66:67], v[150:151], v[140:141], v[66:67] op_sel_hi:[1,0,1]
    v_cvt_pk_bf16_f32 v168, v64, v65
    v_cvt_pk_bf16_f32 v169, v66, v67
    ds_write_b64 v215, v[168:169] offset:8192
    v_pk_fma_f32 v[92:93], v[152:153], v[140:141], v[92:93] op_sel_hi:[1,0,1]
    v_pk_fma_f32 v[94:95], v[154:155], v[140:141], v[94:95] op_sel_hi:[1,0,1]
    v_pk_mul_f32 v[92:93], v[92:93], v[140:141] op_sel:[0,1] op_sel_hi:[1,1]
    v_pk_mul_f32 v[94:95], v[94:95], v[140:141] op_sel:[0,1] op_sel_hi:[1,1]
    v_cvt_pk_bf16_f32 v170, v92, v93
    v_cvt_pk_bf16_f32 v171, v94, v95
    ds_write_b64 v215, v[170:171] offset:22528
    v_pk_fma_f32 v[68:69], v[148:149], v[142:143], v[68:69] op_sel_hi:[1,0,1]
    v_pk_fma_f32 v[70:71], v[150:151], v[142:143], v[70:71] op_sel_hi:[1,0,1]
    v_cvt_pk_bf16_f32 v160, v68, v69
    v_cvt_pk_bf16_f32 v161, v70, v71
    ds_write_b64 v215, v[160:161] offset:10240
    v_pk_fma_f32 v[96:97], v[152:153], v[142:143], v[96:97] op_sel_hi:[1,0,1]
    v_pk_fma_f32 v[98:99], v[154:155], v[142:143], v[98:99] op_sel_hi:[1,0,1]
    v_pk_mul_f32 v[96:97], v[96:97], v[142:143] op_sel:[0,1] op_sel_hi:[1,1]
    v_pk_mul_f32 v[98:99], v[98:99], v[142:143] op_sel:[0,1] op_sel_hi:[1,1]
    v_cvt_pk_bf16_f32 v162, v96, v97
    v_cvt_pk_bf16_f32 v163, v98, v99
    ds_write_b64 v215, v[162:163] offset:24576
    v_pk_fma_f32 v[104:105], v[156:157], v[132:133], v[104:105] op_sel_hi:[1,0,1]
    v_pk_fma_f32 v[106:107], v[158:159], v[132:133], v[106:107] op_sel_hi:[1,0,1]
    v_pk_mul_f32 v[104:105], v[104:105], v[132:133] op_sel:[0,1] op_sel_hi:[1,1]
    v_pk_mul_f32 v[106:107], v[106:107], v[132:133] op_sel:[0,1] op_sel_hi:[1,1]
    v_cvt_pk_bf16_f32 v164, v104, v105
    v_cvt_pk_bf16_f32 v165, v106, v107
    ds_write_b64 v215, v[164:165] offset:28672
    v_pk_fma_f32 v[108:109], v[156:157], v[134:135], v[108:109] op_sel_hi:[1,0,1]
    v_pk_fma_f32 v[110:111], v[158:159], v[134:135], v[110:111] op_sel_hi:[1,0,1]
    v_pk_mul_f32 v[108:109], v[108:109], v[134:135] op_sel:[0,1] op_sel_hi:[1,1]
    v_pk_mul_f32 v[110:111], v[110:111], v[134:135] op_sel:[0,1] op_sel_hi:[1,1]
    v_cvt_pk_bf16_f32 v166, v108, v109
    v_cvt_pk_bf16_f32 v167, v110, v111
    ds_write_b64 v215, v[166:167] offset:30720
    v_pk_fma_f32 v[112:113], v[156:157], v[136:137], v[112:113] op_sel_hi:[1,0,1]
    v_pk_fma_f32 v[114:115], v[158:159], v[136:137], v[114:115] op_sel_hi:[1,0,1]
    v_pk_mul_f32 v[112:113], v[112:113], v[136:137] op_sel:[0,1] op_sel_hi:[1,1]
    v_pk_mul_f32 v[114:115], v[114:115], v[136:137] op_sel:[0,1] op_sel_hi:[1,1]
    v_cvt_pk_bf16_f32 v168, v112, v113
    v_cvt_pk_bf16_f32 v169, v114, v115
    ds_write_b64 v215, v[168:169] offset:32768
    v_pk_fma_f32 v[116:117], v[156:157], v[138:139], v[116:117] op_sel_hi:[1,0,1]
    v_pk_fma_f32 v[118:119], v[158:159], v[138:139], v[118:119] op_sel_hi:[1,0,1]
    v_pk_mul_f32 v[116:117], v[116:117], v[138:139] op_sel:[0,1] op_sel_hi:[1,1]
    v_pk_mul_f32 v[118:119], v[118:119], v[138:139] op_sel:[0,1] op_sel_hi:[1,1]
    v_cvt_pk_bf16_f32 v170, v116, v117
    v_cvt_pk_bf16_f32 v171, v118, v119
    ds_write_b64 v215, v[170:171] offset:34816
    v_pk_fma_f32 v[120:121], v[156:157], v[140:141], v[120:121] op_sel_hi:[1,0,1]
    v_pk_fma_f32 v[122:123], v[158:159], v[140:141], v[122:123] op_sel_hi:[1,0,1]
    v_pk_mul_f32 v[120:121], v[120:121], v[140:141] op_sel:[0,1] op_sel_hi:[1,1]
    v_pk_mul_f32 v[122:123], v[122:123], v[140:141] op_sel:[0,1] op_sel_hi:[1,1]
    v_cvt_pk_bf16_f32 v160, v120, v121
    v_cvt_pk_bf16_f32 v161, v122, v123
    ds_write_b64 v215, v[160:161] offset:36864
    v_pk_fma_f32 v[124:125], v[156:157], v[142:143], v[124:125] op_sel_hi:[1,0,1]
    v_pk_fma_f32 v[126:127], v[158:159], v[142:143], v[126:127] op_sel_hi:[1,0,1]
    v_pk_mul_f32 v[124:125], v[124:125], v[142:143] op_sel:[0,1] op_sel_hi:[1,1]
    v_pk_mul_f32 v[126:127], v[126:127], v[142:143] op_sel:[0,1] op_sel_hi:[1,1]
    v_cvt_pk_bf16_f32 v162, v124, v125
    v_cvt_pk_bf16_f32 v163, v126, v127
    ds_write_b64 v215, v[162:163] offset:38912
    v_pk_fma_f32 v[128:129], v[156:157], v[144:145], v[128:129] op_sel_hi:[1,0,1]
    v_pk_fma_f32 v[130:131], v[158:159], v[144:145], v[130:131] op_sel_hi:[1,0,1]
    v_pk_mul_f32 v[128:129], v[128:129], v[144:145] op_sel:[0,1] op_sel_hi:[1,1]
    v_pk_mul_f32 v[130:131], v[130:131], v[144:145] op_sel:[0,1] op_sel_hi:[1,1]
    v_cvt_pk_bf16_f32 v164, v128, v129
    v_cvt_pk_bf16_f32 v165, v130, v131
    ds_write_b64 v215, v[164:165] offset:40960
    s_setprio 1
    s_waitcnt lgkmcnt(0)
L_attn:
    s_barrier
    s_nop 0
    ds_read_b64 v[48:49], v10 offset:0
    ds_read_b64 v[50:51], v14 offset:0
    ds_read_b64 v[64:65], v10 offset:14336
    ds_read_b64 v[66:67], v14 offset:14336
    ds_read_b64 v[80:81], v10 offset:12288
    ds_read_b64 v[82:83], v14 offset:12288
    ds_read_b64 v[60:61], v13 offset:0
    ds_read_b64 v[62:63], v17 offset:0
    ds_read_b64 v[76:77], v13 offset:14336
    ds_read_b64 v[78:79], v17 offset:14336
    ds_read_b64 v[92:93], v13 offset:12288
    ds_read_b64 v[94:95], v17 offset:12288
    s_waitcnt lgkmcnt(6)
    v_mfma_f32_16x16x32_bf16 v[96:99], v[64:67], v[48:51], v[28:31]
    v_mfma_f32_16x16x32_bf16 v[112:115], v[80:83], v[48:51], v[32:35]
    s_waitcnt lgkmcnt(0)
    v_mfma_f32_16x16x32_bf16 v[108:111], v[76:79], v[60:63], v[28:31]
    v_mfma_f32_16x16x32_bf16 v[124:127], v[92:95], v[60:63], v[32:35]
    ds_read_b64 v[52:53], v11 offset:0
    ds_read_b64 v[54:55], v15 offset:0
    ds_read_b64 v[68:69], v11 offset:14336
    ds_read_b64 v[70:71], v15 offset:14336
    ds_read_b64 v[84:85], v11 offset:12288
    ds_read_b64 v[86:87], v15 offset:12288
    s_cmp_eq_u32 s3, 0
    v_max_f32 v96, v96, v112
    v_max_f32 v97, v97, v113
    v_max_f32 v98, v98, v114
    v_max_f32_e64 v99, v99, v115
    v_and_or_b32 v224, v96, v39, s74
    v_and_or_b32 v225, v97, v39, s75
    v_and_or_b32 v226, v98, v39, s76
    v_and_or_b32 v227, v99, v39, s77
    v_max_f32 v108, v108, v124
    v_max_f32 v109, v109, v125
    v_max_f32 v110, v110, v126
    v_max_f32 v111, v111, v127
    v_and_or_b32 v228, v108, v39, s70
    v_and_or_b32 v229, v109, v39, s71
    v_and_or_b32 v230, v110, v39, s72
    v_and_or_b32 v231, v111, v39, s73
    s_cbranch_scc1 L_xfar
    s_nop 0
    buffer_store_dwordx4 v[224:227], v8, s[20:23], s7 offen
    buffer_store_dwordx4 v[228:231], v8, s[20:23], s100 offen
L_xsent:
    ds_read_b64 v[56:57], v12 offset:0
    ds_read_b64 v[58:59], v16 offset:0
    ds_read_b64 v[72:73], v12 offset:14336
    ds_read_b64 v[74:75], v16 offset:14336
    ds_read_b64 v[88:89], v12 offset:12288
    ds_read_b64 v[90:91], v16 offset:12288
    ds_read_b64 v[232:233], v38
    s_waitcnt lgkmcnt(7)
    v_mfma_f32_16x16x32_bf16 v[100:103], v[68:71], v[52:55], v[28:31]
    v_mfma_f32_16x16x32_bf16 v[116:119], v[84:87], v[52:55], v[32:35]
    s_waitcnt lgkmcnt(1)
    v_mfma_f32_16x16x32_bf16 v[104:107], v[72:75], v[56:59], v[28:31]
    v_mfma_f32_16x16x32_bf16 v[120:123], v[88:91], v[56:59], v[32:35]
    ds_read_b64 v[44:45], v9
    ds_read_b64_tr_b16 v[128:129], v18
    ds_read_b64_tr_b16 v[130:131], v18 offset:2048
    ds_read_b64_tr_b16 v[132:133], v19
    ds_read_b64_tr_b16 v[134:135], v19 offset:2048
    s_cmp_eq_u32 s33, 0
    s_cselect_b32 s51, 2130706432, s6
    v_max_f32 v100, v100, v116
    v_max_f32 v101, v101, v117
    v_max_f32 v102, v102, v118
    v_max_f32 v103, v103, v119
    s_waitcnt lgkmcnt(5)
    v_mul_f32 v234, 0x3ea52b5c, v233
    v_max_f32 v104, v104, v120
    v_max_f32 v105, v105, v121
    v_max_f32 v106, v106, v122
    v_max_f32 v107, v107, v123
    v_max3_f32 v236, v100, v101, v102
    v_max3_f32 v238, v104, v105, v106
    v_max_f32 v236, v236, v103
    v_max_f32 v238, v238, v107
    ds_read_b64_tr_b16 v[140:141], v21
    ds_read_b64_tr_b16 v[142:143], v21 offset:2048
    v_permlane32_swap_b32 v236, v238
    v_max_f32 v236, v236, v238
    v_mov_b32_e64 v238, v236
    ds_read_b64_tr_b16 v[136:137], v20
    ds_read_b64_tr_b16 v[138:139], v20 offset:2048
    v_permlane16_swap_b32 v236, v238
    v_max_f32 v236, v236, v238
    v_mul_f32 v238, v236, v234
    v_mul_f32 v236, v236, v234
    ds_read_b64_tr_b16 v[144:145], v22
    ds_read_b64_tr_b16 v[146:147], v22 offset:2048
    v_permlane32_swap_b32 v236, v238
    s_nop 0
    v_fma_f32 v100, v100, v234, -v236
    v_fma_f32 v101, v101, v234, -v236
    v_fma_f32 v102, v102, v234, -v236
    v_fma_f32 v103, v103, v234, -v236
    v_fma_f32 v104, v104, v234, -v238
    v_fma_f32 v105, v105, v234, -v238
    v_fma_f32 v106, v106, v234, -v238
    v_fma_f32 v107, v107, v234, -v238
    v_exp_f32 v100, v100
    v_exp_f32 v101, v101
    v_exp_f32 v102, v102
    v_exp_f32 v103, v103
    v_exp_f32 v104, v104
    v_exp_f32 v105, v105
    v_exp_f32 v106, v106
    v_exp_f32 v107, v107
    ds_read_b64_tr_b16 v[148:149], v23
    ds_read_b64_tr_b16 v[150:151], v23 offset:2048
    v_cvt_pk_bf16_f32 v174, v100, v101
    v_cvt_pk_bf16_f32 v175, v102, v103
    v_and_b32 v172, v174, v36
    v_and_b32 v173, v175, v37
    v_xor_b32 v174, v172, v174
    v_xor_b32 v175, v173, v175
    v_cvt_pk_bf16_f32 v178, v104, v105
    v_cvt_pk_bf16_f32 v179, v106, v107
    v_and_b32 v176, v178, v36
    v_and_b32 v177, v179, v37
    v_xor_b32 v178, v176, v178
    v_xor_b32_e64 v179, v177, v179
    s_cmp_eq_u32 s33, 4
    s_cselect_b32 s50, 2130706432, s6
    buffer_load_dwordx4 v[216:219], v8, s[20:23], s51 offen sc1
    buffer_load_dwordx4 v[220:223], v8, s[20:23], s50 offen offset:1024 sc1
    s_setprio 0
    v_mfma_f32_16x16x32_bf16 v[204:207], v[40:43], v[172:175], 0
    s_waitcnt lgkmcnt(10)
    v_mfma_f32_16x16x32_bf16 v[184:187], v[128:131], v[172:175], 0
    s_waitcnt lgkmcnt(8)
    v_mfma_f32_16x16x32_bf16 v[188:191], v[132:135], v[172:175], 0
    s_waitcnt lgkmcnt(6)
    v_mfma_f32_16x16x32_bf16 v[192:195], v[140:143], v[172:175], 0
    v_mfma_f32_16x16x32_bf16 v[208:211], v[40:43], v[176:179], 0
    s_waitcnt lgkmcnt(4)
    v_mfma_f32_16x16x32_bf16 v[188:191], v[136:139], v[176:179], v[188:191]
    s_waitcnt lgkmcnt(2)
    v_mfma_f32_16x16x32_bf16 v[192:195], v[144:147], v[176:179], v[192:195]
    s_waitcnt lgkmcnt(0)
    s_nop 0
    v_mfma_f32_16x16x32_bf16 v[196:199], v[148:151], v[176:179], 0
    ds_read_b64_tr_b16 v[152:153], v24
    ds_read_b64_tr_b16 v[154:155], v24 offset:2048
    ds_read_b64_tr_b16 v[156:157], v25
    ds_read_b64_tr_b16 v[158:159], v25 offset:2048
    ds_read_b64_tr_b16 v[160:161], v26
    ds_read_b64_tr_b16 v[162:163], v26 offset:2048
    ds_read_b64_tr_b16 v[164:165], v27
    ds_read_b64_tr_b16 v[166:167], v27 offset:2048
    v_readfirstlane_b32 s98, v44
    v_readfirstlane_b32 s99, v45
    s_mov_b32 s46, 262144
L_xp:
    s_waitcnt vmcnt(0)
    v_xor_b32 v216, s74, v216
    v_xor_b32 v217, s75, v217
    v_xor_b32 v218, s76, v218
    v_xor_b32 v219, s77, v219
    v_xor_b32 v220, s70, v220
    v_xor_b32 v221, s71, v221
    v_xor_b32 v222, s72, v222
    v_xor_b32_e64 v223, s73, v223
    v_or3_b32 v244, v216, v217, v218
    v_or3_b32 v245, v219, v220, v221
    v_or3_b32 v244, v244, v222, v223
    v_or_b32_e64 v244, v244, v245
    v_and_b32 v244, 0xff, v244
    v_cmp_ne_u32 vcc, 0, v244
    s_cmp_lg_u64 vcc, 0
    s_cbranch_scc1 L_xretry
L_xp_ok:
    v_add_f32 v96, v96, v216
    v_add_f32 v97, v97, v217
    v_add_f32 v98, v98, v218
    v_add_f32 v99, v99, v219
    v_add_f32 v108, v108, v220
    v_add_f32 v109, v109, v221
    v_add_f32 v110, v110, v222
    v_add_f32_e64 v111, v111, v223
    v_max3_f32 v236, v96, v97, v98
    v_max3_f32 v238, v108, v109, v110
    v_max_f32 v236, v236, v99
    v_max_f32 v238, v238, v111
    v_lshrrev_b32_e64 v52, 2, v0
    v_bfe_u32 v53, v0, 3, 2
    v_permlane32_swap_b32 v236, v238
    v_max_f32 v236, v236, v238
    v_mov_b32 v238, v236
    v_and_b32 v54, 3, v0
    v_lshlrev_b32 v52, 7, v52
    v_permlane16_swap_b32 v236, v238
    v_max_f32 v236, v236, v238
    v_mul_f32 v238, v236, v234
    v_mul_f32_e64 v236, v236, v234
    v_lshl_add_u32 v52, v54, 3, v52
    v_lshlrev_b32 v53, 5, v53
    v_permlane32_swap_b32 v236, v238
    v_fma_f32 v96, v96, v234, -v236
    v_fma_f32 v97, v97, v234, -v236
    v_fma_f32 v98, v98, v234, -v236
    v_fma_f32 v99, v99, v234, -v236
    v_fma_f32 v108, v108, v234, -v238
    v_fma_f32 v109, v109, v234, -v238
    v_fma_f32 v110, v110, v234, -v238
    v_fma_f32 v111, v111, v234, -v238
    v_exp_f32 v96, v96
    v_exp_f32 v97, v97
    v_exp_f32 v98, v98
    v_exp_f32 v99, v99
    v_exp_f32 v108, v108
    v_exp_f32 v109, v109
    v_exp_f32 v110, v110
    v_exp_f32 v111, v111
    v_add_u32 v52, 34816, v52
    v_cvt_pk_bf16_f32 v170, v96, v97
    v_cvt_pk_bf16_f32 v171, v98, v99
    v_and_b32 v168, v170, v36
    v_and_b32 v169, v171, v37
    v_xor_b32 v170, v168, v170
    v_xor_b32 v171, v169, v171
    v_cvt_pk_bf16_f32 v182, v108, v109
    v_cvt_pk_bf16_f32 v183, v110, v111
    v_and_b32 v180, v182, v36
    v_and_b32 v181, v183, v37
    v_xor_b32 v182, v180, v182
    v_xor_b32 v183, v181, v183
    v_mfma_f32_16x16x32_bf16 v[200:203], v[40:43], v[168:171], 0
    s_nop 0
    v_mfma_f32_16x16x32_bf16 v[212:215], v[40:43], v[180:183], 0
    s_waitcnt lgkmcnt(6)
    v_mfma_f32_16x16x32_bf16 v[184:187], v[152:155], v[168:171], v[184:187]
    s_waitcnt lgkmcnt(2)
    v_mfma_f32_16x16x32_bf16 v[192:195], v[160:163], v[180:183], v[192:195]
    v_mfma_f32_16x16x32_bf16 v[188:191], v[156:159], v[168:171], v[188:191]
    s_waitcnt lgkmcnt(0)
    v_mfma_f32_16x16x32_bf16 v[196:199], v[164:167], v[180:183], v[196:199]
    s_movk_i32 s47, 96
    s_nop 0
    v_xad_u32 v10, 0, v53, v52
    v_xad_u32 v11, 32, v53, v52
    v_xad_u32 v12, 64, v53, v52
    v_xad_u32 v13, s47, v53, v52
    v_cndmask_b32 v236, v200, v204, s[58:59]
    v_cndmask_b32 v237, v200, v204, s[60:61]
    v_cndmask_b32 v238, v204, v208, s[64:65]
    v_cndmask_b32 v239, v208, v212, s[68:69]
    v_cndmask_b32 v237, v237, v208, s[62:63]
    v_cndmask_b32 v238, v238, v212, s[66:67]
    v_rcp_f32 v236, v236
    v_rcp_f32 v237, v237
    v_rcp_f32 v238, v238
    v_rcp_f32 v239, v239
    s_add_u32 s50, s6, 153600
    v_mul_f32 v184, v184, v236
    v_mul_f32 v185, v185, v236
    v_mul_f32 v186, v186, v236
    v_mul_f32 v187, v187, v236
    v_cvt_pk_bf16_f32 v24, v184, v185
    v_cvt_pk_bf16_f32 v25, v186, v187
    v_mul_f32 v188, v188, v237
    v_mul_f32 v189, v189, v237
    v_mul_f32 v190, v190, v237
    v_mul_f32 v191, v191, v237
    v_cvt_pk_bf16_f32 v26, v188, v189
    v_cvt_pk_bf16_f32 v27, v190, v191
    buffer_store_dwordx4 v[24:27], v8, s[20:23], s50 offen offset:0 sc1
    v_mul_f32 v192, v192, v238
    v_mul_f32 v193, v193, v238
    v_mul_f32 v194, v194, v238
    v_mul_f32 v195, v195, v238
    v_cvt_pk_bf16_f32 v28, v192, v193
    v_cvt_pk_bf16_f32 v29, v194, v195
    v_mul_f32 v196, v196, v239
    v_mul_f32 v197, v197, v239
    v_mul_f32 v198, v198, v239
    v_mul_f32 v199, v199, v239
    v_cvt_pk_bf16_f32 v30, v196, v197
    v_cvt_pk_bf16_f32 v31, v198, v199
    buffer_store_dwordx4 v[28:31], v8, s[20:23], s50 offen offset:1024 sc1
    buffer_store_dwordx4 v[24:27], v8, s[20:23], s6 offen offset:0
    buffer_store_dwordx4 v[28:31], v8, s[20:23], s6 offen offset:1024
    s_and_b32 s48, s98, s99
    s_cmp_eq_u32 s48, -1
    s_cbranch_scc0 L_ysig
L_ysig_ok:
    v_add_f32 v2, 1.0, v233
    v_mul_f32 v4, v232, v233
    s_lshl_b32 s48, s44, 4
    v_add_u32 v52, s48, v5
    v_and_b32 v54, 1, v6
    v_lshrrev_b32 v55, 1, v6
    v_lshlrev_b32 v57, 7, v52
    v_lshl_add_u32 v57, v54, 3, v57
    v_bfe_u32 v58, v0, 1, 3
    v_xor_b32 v58, v58, v55
    v_lshlrev_b32 v58, 4, v58
    v_xad_u32 v20, 0, v58, v57
    ds_read_b64 v[64:65], v20
    v_xad_u32 v21, 32, v58, v57
    ds_read_b64 v[66:67], v21
    v_xad_u32 v22, 64, v58, v57
    ds_read_b64 v[68:69], v22
    v_xad_u32 v23, s47, v58, v57
    ds_read_b64 v[70:71], v23
    s_lshl_b32 s47, s44, 7
    s_add_u32 s47, s47, 14336
    s_add_u32 s50, s47, s4
    s_mul_i32 s48, s33, 15360
    s_cmp_eq_u32 s3, 0
    s_cselect_b32 s49, 153600, 0
    s_sub_u32 s48, s49, s48
    s_add_u32 s52, s4, 14336
    s_cmp_eq_u32 s3, 0
    s_cselect_b32 s52, s52, s50
    s_add_u32 s52, s52, s48
    s_add_u32 s51, s6, s48
    s_add_u32 s53, s6, s49
    s_add_u32 s56, s51, 76800
    v_mov_b32 v48, s31
    v_mov_b32 v49, 0
    v_min_u32 v19, 4, v0
    v_mul_u32_u24 v19, 15360, v19
    ds_read_b64_tr_b16 v[96:97], v10 offset:4096
    ds_read_b64_tr_b16 v[98:99], v10 offset:6144
    ds_read_b64_tr_b16 v[100:101], v11 offset:4096
    ds_read_b64_tr_b16 v[102:103], v11 offset:6144
    ds_read_b64_tr_b16 v[104:105], v12 offset:4096
    ds_read_b64_tr_b16 v[106:107], v12 offset:6144
    ds_read_b64_tr_b16 v[108:109], v13 offset:4096
    ds_read_b64_tr_b16 v[110:111], v13 offset:6144
    s_waitcnt lgkmcnt(8)
    v_lshlrev_b32 v32, 16, v64
    v_and_b32 v33, 0xffff0000, v64
    v_fma_f32 v32, v32, v2, v4
    v_fma_f32 v33, v33, v2, v4
    ds_read_b64_tr_b16 v[112:113], v10 offset:8192
    ds_read_b64_tr_b16 v[114:115], v10 offset:10240
    v_lshlrev_b32_e64 v34, 16, v65
    v_and_b32 v35, 0xffff0000, v65
    v_fma_f32 v34, v34, v2, v4
    v_fma_f32 v35, v35, v2, v4
    ds_read_b64_tr_b16 v[116:117], v11 offset:8192
    ds_read_b64_tr_b16 v[118:119], v11 offset:10240
    v_lshlrev_b32_e64 v36, 16, v66
    v_and_b32 v37, 0xffff0000, v66
    v_fma_f32 v36, v36, v2, v4
    v_fma_f32 v37, v37, v2, v4
    ds_read_b64_tr_b16 v[120:121], v12 offset:8192
    ds_read_b64_tr_b16 v[122:123], v12 offset:10240
    v_lshlrev_b32_e64 v38, 16, v67
    v_and_b32 v39, 0xffff0000, v67
    v_fma_f32 v38, v38, v2, v4
    v_fma_f32 v39, v39, v2, v4
    ds_read_b64_tr_b16 v[124:125], v13 offset:8192
    ds_read_b64_tr_b16 v[126:127], v13 offset:10240
    v_lshlrev_b32_e64 v40, 16, v68
    v_and_b32 v41, 0xffff0000, v68
    v_fma_f32 v40, v40, v2, v4
    v_fma_f32 v41, v41, v2, v4
    ds_read_b64_tr_b16 v[128:129], v10 offset:12288
    ds_read_b64_tr_b16 v[130:131], v10 offset:14336
    v_lshlrev_b32_e64 v42, 16, v69
    v_and_b32 v43, 0xffff0000, v69
    v_fma_f32 v42, v42, v2, v4
    v_fma_f32 v43, v43, v2, v4
    ds_read_b64_tr_b16 v[132:133], v11 offset:12288
    ds_read_b64_tr_b16 v[134:135], v11 offset:14336
    v_lshlrev_b32_e64 v44, 16, v70
    v_and_b32 v45, 0xffff0000, v70
    v_fma_f32 v44, v44, v2, v4
    v_fma_f32 v45, v45, v2, v4
    ds_read_b64_tr_b16 v[136:137], v12 offset:12288
    ds_read_b64_tr_b16 v[138:139], v12 offset:14336
    v_lshlrev_b32_e64 v46, 16, v71
    v_and_b32 v47, 0xffff0000, v71
    v_fma_f32 v46, v46, v2, v4
    v_fma_f32 v47, v47, v2, v4
    ds_read_b64_tr_b16 v[140:141], v13 offset:12288
    ds_read_b64_tr_b16 v[142:143], v13 offset:14336
    v_mov_b32 v9, 116744
    v_mov_b32 v50, 1
    s_waitcnt lgkmcnt(8)
    v_mfma_f32_16x16x32_bf16 v[32:35], v[96:99], v[24:27], v[32:35]
    ds_read_b64_tr_b16 v[144:145], v10 offset:16384
    v_mfma_f32_16x16x32_bf16 v[36:39], v[100:103], v[24:27], v[36:39]
    ds_read_b64_tr_b16 v[146:147], v10 offset:18432
    v_mfma_f32_16x16x32_bf16 v[40:43], v[104:107], v[24:27], v[40:43]
    ds_read_b64_tr_b16 v[148:149], v11 offset:16384
    v_mfma_f32_16x16x32_bf16 v[44:47], v[108:111], v[24:27], v[44:47]
    ds_read_b64_tr_b16 v[150:151], v11 offset:18432
    v_mfma_f32_16x16x32_bf16 v[32:35], v[112:115], v[28:31], v[32:35]
    ds_read_b64_tr_b16 v[152:153], v12 offset:16384
    v_mfma_f32_16x16x32_bf16 v[36:39], v[116:119], v[28:31], v[36:39]
    ds_read_b64_tr_b16 v[154:155], v12 offset:18432
    v_mfma_f32_16x16x32_bf16 v[40:43], v[120:123], v[28:31], v[40:43]
    ds_read_b64_tr_b16 v[156:157], v13 offset:16384
    v_mfma_f32_16x16x32_bf16 v[44:47], v[124:127], v[28:31], v[44:47]
    ds_read_b64_tr_b16 v[158:159], v13 offset:18432
    s_mov_b64 exec, 1
    s_waitcnt vmcnt(0)
    ds_add_u32 v9, v50
    buffer_store_dword v48, v49, s[20:23], s50 offen
    s_mov_b64 exec, -1
    s_nop 0
    buffer_load_dword v1, v19, s[20:23], s52 offen sc1
    ds_read_b64_tr_b16 v[160:161], v10 offset:20480
    ds_read_b64_tr_b16 v[162:163], v10 offset:22528
    ds_read_b64_tr_b16 v[164:165], v11 offset:20480
    ds_read_b64_tr_b16 v[166:167], v11 offset:22528
    ds_read_b64_tr_b16 v[168:169], v12 offset:20480
    ds_read_b64_tr_b16 v[170:171], v12 offset:22528
    ds_read_b64_tr_b16 v[172:173], v13 offset:20480
    ds_read_b64_tr_b16 v[174:175], v13 offset:22528
    ds_read_b64_tr_b16 v[176:177], v10 offset:24576
    ds_read_b64_tr_b16 v[178:179], v10 offset:26624
    ds_read_b64_tr_b16 v[180:181], v11 offset:24576
    ds_read_b64_tr_b16 v[182:183], v11 offset:26624
    s_waitcnt vmcnt(0)
    v_cmp_ne_u32 vcc, s31, v1
    s_cmp_lg_u64 vcc, 0
    s_cbranch_scc1 L_fretry
L_fpoll_ok:
    s_add_u32 s53, s53, 15360
    s_cmp_eq_u32 s53, s56
    s_cselect_b32 s53, s51, s53
    buffer_load_dwordx4 v[64:67], v8, s[20:23], s53 offen offset:0 sc1
    buffer_load_dwordx4 v[68:71], v8, s[20:23], s53 offen offset:1024 sc1
    s_add_u32 s53, s53, 15360
    s_cmp_eq_u32 s53, s56
    s_cselect_b32 s53, s51, s53
    buffer_load_dwordx4 v[72:75], v8, s[20:23], s53 offen offset:0 sc1
    buffer_load_dwordx4 v[76:79], v8, s[20:23], s53 offen offset:1024 sc1
    v_add_u32 v14, 40960, v10
    ds_read_b64_tr_b16 v[184:185], v12 offset:24576
    v_add_u32 v15, 40960, v11
    ds_read_b64_tr_b16 v[186:187], v12 offset:26624
    v_add_u32 v16, 40960, v12
    ds_read_b64_tr_b16 v[188:189], v13 offset:24576
    v_add_u32 v17, 40960, v13
    ds_read_b64_tr_b16 v[190:191], v13 offset:26624
    s_lshl_b32 s47, s44, 11
    ds_read_b64_tr_b16 v[192:193], v10 offset:28672
    s_add_u32 s54, s45, s47
    ds_read_b64_tr_b16 v[194:195], v10 offset:30720
    s_cmp_ge_u32 s34, 5
    ds_read_b64_tr_b16 v[196:197], v11 offset:28672
    s_cselect_b32 s48, 0, 76800
    ds_read_b64_tr_b16 v[198:199], v11 offset:30720
    s_add_u32 s54, s54, s48
    ds_read_b64_tr_b16 v[200:201], v12 offset:28672
    s_add_u32 s54, s54, 153600
    ds_read_b64_tr_b16 v[202:203], v12 offset:30720
    s_lshl_b32 s47, s34, 7
    ds_read_b64_tr_b16 v[204:205], v13 offset:28672
    s_add_u32 s47, s47, s38
    ds_read_b64_tr_b16 v[206:207], v13 offset:30720
    v_mul_u32_u24 v53, 2560, v52
    ds_read_b64_tr_b16 v[208:209], v10 offset:32768
    v_add_u32_e64 v53, s47, v53
    ds_read_b64_tr_b16 v[210:211], v10 offset:34816
    v_lshl_add_u32 v53, v54, 5, v53
    ds_read_b64_tr_b16 v[212:213], v11 offset:32768
    v_lshl_add_u32 v53, v55, 4, v53
    ds_read_b64_tr_b16 v[214:215], v11 offset:34816
    s_cmp_eq_u32 s35, 0
    ds_read_b64_tr_b16 v[216:217], v12 offset:32768
    s_cselect_b32 s47, 0, 7
    ds_read_b64_tr_b16 v[218:219], v12 offset:34816
    s_sub_u32 s48, 111, s47
    ds_read_b64_tr_b16 v[220:221], v13 offset:32768
    v_subrev_u32_e64 v56, s47, v52
    ds_read_b64_tr_b16 v[222:223], v13 offset:34816
    v_cmp_gt_u32_e64 vcc, s48, v56
    v_mov_b32 v56, 2130706432
    s_mov_b32 s46, 262144
    s_lshr_b32 s47, s98, 4
    s_cmp_eq_u32 s47, s44
    s_cselect_b32 s49, 1, 0
    s_lshr_b32 s47, s99, 4
    s_cmp_eq_u32 s47, s44
    s_cselect_b32 s49, 1, s49
    v_cndmask_b32 v18, v56, v53, vcc
    s_waitcnt vmcnt(3)
    s_waitcnt lgkmcnt(14)
    v_mfma_f32_16x16x32_bf16 v[32:35], v[128:131], v[64:67], v[32:35]
    ds_read_b64_tr_b16 v[224:225], v10 offset:36864
    ds_read_b64_tr_b16 v[226:227], v10 offset:38912
    v_mfma_f32_16x16x32_bf16 v[36:39], v[132:135], v[64:67], v[36:39]
    ds_read_b64_tr_b16 v[228:229], v11 offset:36864
    s_add_u32 s53, s53, 15360
    s_cmp_eq_u32 s53, s56
    s_cselect_b32 s53, s51, s53
    buffer_load_dwordx4 v[80:83], v8, s[20:23], s53 offen offset:0 sc1
    v_mfma_f32_16x16x32_bf16 v[40:43], v[136:139], v[64:67], v[40:43]
    ds_read_b64_tr_b16 v[230:231], v11 offset:38912
    ds_read_b64_tr_b16 v[232:233], v12 offset:36864
    v_mfma_f32_16x16x32_bf16 v[44:47], v[140:143], v[64:67], v[44:47]
    ds_read_b64_tr_b16 v[234:235], v12 offset:38912
    buffer_load_dwordx4 v[84:87], v8, s[20:23], s53 offen offset:1024 sc1
    s_waitcnt vmcnt(4)
    v_mfma_f32_16x16x32_bf16 v[32:35], v[144:147], v[68:71], v[32:35]
    ds_read_b64_tr_b16 v[236:237], v13 offset:36864
    ds_read_b64_tr_b16 v[238:239], v13 offset:38912
    v_mfma_f32_16x16x32_bf16 v[36:39], v[148:151], v[68:71], v[36:39]
    ds_read_b64_tr_b16 v[240:241], v14 offset:0
    s_add_u32 s53, s53, 15360
    s_cmp_eq_u32 s53, s56
    s_cselect_b32 s53, s51, s53
    buffer_load_dwordx4 v[88:91], v8, s[20:23], s53 offen offset:0 sc1
    v_mfma_f32_16x16x32_bf16 v[40:43], v[152:155], v[68:71], v[40:43]
    ds_read_b64_tr_b16 v[242:243], v14 offset:2048
    ds_read_b64_tr_b16 v[244:245], v15 offset:0
    v_mfma_f32_16x16x32_bf16 v[44:47], v[156:159], v[68:71], v[44:47]
    ds_read_b64_tr_b16 v[246:247], v15 offset:2048
    buffer_load_dwordx4 v[92:95], v8, s[20:23], s53 offen offset:1024 sc1
    s_waitcnt vmcnt(5)
    v_mfma_f32_16x16x32_bf16 v[32:35], v[160:163], v[72:75], v[32:35]
    ds_read_b64_tr_b16 v[248:249], v16 offset:0
    ds_read_b64_tr_b16 v[250:251], v16 offset:2048
    v_mfma_f32_16x16x32_bf16 v[36:39], v[164:167], v[72:75], v[36:39]
    ds_read_b64_tr_b16 v[252:253], v17 offset:0
    v_mfma_f32_16x16x32_bf16 v[40:43], v[168:171], v[72:75], v[40:43]
    ds_read_b64_tr_b16 v[254:255], v17 offset:2048
    v_mfma_f32_16x16x32_bf16 v[44:47], v[172:175], v[72:75], v[44:47]
    s_barrier
    s_waitcnt vmcnt(4)
    v_mfma_f32_16x16x32_bf16 v[32:35], v[176:179], v[76:79], v[32:35]
    ds_read_b64_tr_b16 v[96:97], v14 offset:4096
    ds_read_b64_tr_b16 v[98:99], v14 offset:6144
    v_mfma_f32_16x16x32_bf16 v[36:39], v[180:183], v[76:79], v[36:39]
    ds_read_b64_tr_b16 v[100:101], v15 offset:4096
    buffer_load_dwordx4 v[48:51], v8, s[20:23], s54 offen offset:0 sc1
    v_mfma_f32_16x16x32_bf16 v[40:43], v[184:187], v[76:79], v[40:43]
    ds_read_b64_tr_b16 v[102:103], v15 offset:6144
    ds_read_b64_tr_b16 v[104:105], v16 offset:4096
    v_mfma_f32_16x16x32_bf16 v[44:47], v[188:191], v[76:79], v[44:47]
    ds_read_b64_tr_b16 v[106:107], v16 offset:6144
    buffer_load_dwordx4 v[52:55], v8, s[20:23], s54 offen offset:1024 sc1
    s_add_u32 s54, s54, 15360
    s_waitcnt vmcnt(5)
    s_waitcnt lgkmcnt(14)
    v_mfma_f32_16x16x32_bf16 v[32:35], v[192:195], v[80:83], v[32:35]
    ds_read_b64_tr_b16 v[108:109], v17 offset:4096
    ds_read_b64_tr_b16 v[110:111], v17 offset:6144
    v_mfma_f32_16x16x32_bf16 v[36:39], v[196:199], v[80:83], v[36:39]
    ds_read_b64_tr_b16 v[112:113], v14 offset:8192
    buffer_load_dwordx4 v[56:59], v8, s[20:23], s54 offen offset:0 sc1
    v_mfma_f32_16x16x32_bf16 v[40:43], v[200:203], v[80:83], v[40:43]
    ds_read_b64_tr_b16 v[114:115], v14 offset:10240
    ds_read_b64_tr_b16 v[116:117], v15 offset:8192
    v_mfma_f32_16x16x32_bf16 v[44:47], v[204:207], v[80:83], v[44:47]
    ds_read_b64_tr_b16 v[118:119], v15 offset:10240
    buffer_load_dwordx4 v[60:63], v8, s[20:23], s54 offen offset:1024 sc1
    s_add_u32 s54, s54, 15360
    s_waitcnt vmcnt(6)
    v_mfma_f32_16x16x32_bf16 v[32:35], v[208:211], v[84:87], v[32:35]
    ds_read_b64_tr_b16 v[120:121], v16 offset:8192
    ds_read_b64_tr_b16 v[122:123], v16 offset:10240
    v_mfma_f32_16x16x32_bf16 v[36:39], v[212:215], v[84:87], v[36:39]
    ds_read_b64_tr_b16 v[124:125], v17 offset:8192
    buffer_load_dwordx4 v[64:67], v8, s[20:23], s54 offen offset:0 sc1
    v_mfma_f32_16x16x32_bf16 v[40:43], v[216:219], v[84:87], v[40:43]
    ds_read_b64_tr_b16 v[126:127], v17 offset:10240
    ds_read_b64_tr_b16 v[128:129], v14 offset:12288
    v_mfma_f32_16x16x32_bf16 v[44:47], v[220:223], v[84:87], v[44:47]
    ds_read_b64_tr_b16 v[130:131], v14 offset:14336
    buffer_load_dwordx4 v[68:71], v8, s[20:23], s54 offen offset:1024 sc1
    s_add_u32 s54, s54, 15360
    s_waitcnt vmcnt(7)
    v_mfma_f32_16x16x32_bf16 v[32:35], v[224:227], v[88:91], v[32:35]
    ds_read_b64_tr_b16 v[132:133], v15 offset:12288
    ds_read_b64_tr_b16 v[134:135], v15 offset:14336
    v_mfma_f32_16x16x32_bf16 v[36:39], v[228:231], v[88:91], v[36:39]
    ds_read_b64_tr_b16 v[136:137], v16 offset:12288
    buffer_load_dwordx4 v[72:75], v8, s[20:23], s54 offen offset:0 sc1
    v_mfma_f32_16x16x32_bf16 v[40:43], v[232:235], v[88:91], v[40:43]
    ds_read_b64_tr_b16 v[138:139], v16 offset:14336
    ds_read_b64_tr_b16 v[140:141], v17 offset:12288
    v_mfma_f32_16x16x32_bf16 v[44:47], v[236:239], v[88:91], v[44:47]
    ds_read_b64_tr_b16 v[142:143], v17 offset:14336
    buffer_load_dwordx4 v[76:79], v8, s[20:23], s54 offen offset:1024 sc1
    s_add_u32 s54, s54, 15360
    s_waitcnt vmcnt(8)
    s_waitcnt lgkmcnt(14)
    v_mfma_f32_16x16x32_bf16 v[32:35], v[240:243], v[92:95], v[32:35]
    ds_read_b64_tr_b16 v[144:145], v14 offset:16384
    ds_read_b64_tr_b16 v[146:147], v14 offset:18432
    v_mfma_f32_16x16x32_bf16 v[36:39], v[244:247], v[92:95], v[36:39]
    ds_read_b64_tr_b16 v[148:149], v15 offset:16384
    buffer_load_dwordx4 v[80:83], v8, s[20:23], s54 offen offset:0 sc1
    v_mfma_f32_16x16x32_bf16 v[40:43], v[248:251], v[92:95], v[40:43]
    ds_read_b64_tr_b16 v[150:151], v15 offset:18432
    ds_read_b64_tr_b16 v[152:153], v16 offset:16384
    v_mfma_f32_16x16x32_bf16 v[44:47], v[252:255], v[92:95], v[44:47]
    ds_read_b64_tr_b16 v[154:155], v16 offset:18432
    buffer_load_dwordx4 v[84:87], v8, s[20:23], s54 offen offset:1024 sc1
    s_waitcnt vmcnt(9)
    v_mfma_f32_16x16x32_bf16 v[32:35], v[96:99], v[48:51], v[32:35]
    ds_read_b64_tr_b16 v[156:157], v17 offset:16384
    ds_read_b64_tr_b16 v[158:159], v17 offset:18432
    v_mfma_f32_16x16x32_bf16 v[36:39], v[100:103], v[48:51], v[36:39]
    ds_read_b64_tr_b16 v[160:161], v14 offset:20480
    v_mfma_f32_16x16x32_bf16 v[40:43], v[104:107], v[48:51], v[40:43]
    ds_read_b64_tr_b16 v[162:163], v14 offset:22528
    ds_read_b64_tr_b16 v[164:165], v15 offset:20480
    v_mfma_f32_16x16x32_bf16 v[44:47], v[108:111], v[48:51], v[44:47]
    ds_read_b64_tr_b16 v[166:167], v15 offset:22528
    s_waitcnt vmcnt(8)
    s_waitcnt lgkmcnt(14)
    v_mfma_f32_16x16x32_bf16 v[32:35], v[112:115], v[52:55], v[32:35]
    ds_read_b64_tr_b16 v[168:169], v16 offset:20480
    ds_read_b64_tr_b16 v[170:171], v16 offset:22528
    v_mfma_f32_16x16x32_bf16 v[36:39], v[116:119], v[52:55], v[36:39]
    ds_read_b64_tr_b16 v[172:173], v17 offset:20480
    v_mfma_f32_16x16x32_bf16 v[40:43], v[120:123], v[52:55], v[40:43]
    ds_read_b64_tr_b16 v[174:175], v17 offset:22528
    ds_read_b64_tr_b16 v[176:177], v14 offset:24576
    v_mfma_f32_16x16x32_bf16 v[44:47], v[124:127], v[52:55], v[44:47]
    ds_read_b64_tr_b16 v[178:179], v14 offset:26624
    s_waitcnt vmcnt(7)
    s_waitcnt lgkmcnt(14)
    v_mfma_f32_16x16x32_bf16 v[32:35], v[128:131], v[56:59], v[32:35]
    ds_read_b64_tr_b16 v[180:181], v15 offset:24576
    ds_read_b64_tr_b16 v[182:183], v15 offset:26624
    v_mfma_f32_16x16x32_bf16 v[36:39], v[132:135], v[56:59], v[36:39]
    ds_read_b64_tr_b16 v[184:185], v16 offset:24576
    v_mfma_f32_16x16x32_bf16 v[40:43], v[136:139], v[56:59], v[40:43]
    ds_read_b64_tr_b16 v[186:187], v16 offset:26624
    ds_read_b64_tr_b16 v[188:189], v17 offset:24576
    v_mfma_f32_16x16x32_bf16 v[44:47], v[140:143], v[56:59], v[44:47]
    ds_read_b64_tr_b16 v[190:191], v17 offset:26624
    s_waitcnt vmcnt(6)
    s_waitcnt lgkmcnt(14)
    v_mfma_f32_16x16x32_bf16 v[32:35], v[144:147], v[60:63], v[32:35]
    ds_read_b64_tr_b16 v[192:193], v14 offset:28672
    ds_read_b64_tr_b16 v[194:195], v14 offset:30720
    v_mfma_f32_16x16x32_bf16 v[36:39], v[148:151], v[60:63], v[36:39]
    ds_read_b64_tr_b16 v[196:197], v15 offset:28672
    v_mfma_f32_16x16x32_bf16 v[40:43], v[152:155], v[60:63], v[40:43]
    ds_read_b64_tr_b16 v[198:199], v15 offset:30720
    ds_read_b64_tr_b16 v[200:201], v16 offset:28672
    v_mfma_f32_16x16x32_bf16 v[44:47], v[156:159], v[60:63], v[44:47]
    ds_read_b64_tr_b16 v[202:203], v16 offset:30720
    s_waitcnt vmcnt(5)
    s_waitcnt lgkmcnt(14)
    v_mfma_f32_16x16x32_bf16 v[32:35], v[160:163], v[64:67], v[32:35]
    ds_read_b64_tr_b16 v[204:205], v17 offset:28672
    ds_read_b64_tr_b16 v[206:207], v17 offset:30720
    v_mfma_f32_16x16x32_bf16 v[36:39], v[164:167], v[64:67], v[36:39]
    ds_read_b64_tr_b16 v[208:209], v14 offset:32768
    v_mfma_f32_16x16x32_bf16 v[40:43], v[168:171], v[64:67], v[40:43]
    ds_read_b64_tr_b16 v[210:211], v14 offset:34816
    ds_read_b64_tr_b16 v[212:213], v15 offset:32768
    v_mfma_f32_16x16x32_bf16 v[44:47], v[172:175], v[64:67], v[44:47]
    ds_read_b64_tr_b16 v[214:215], v15 offset:34816
    s_waitcnt vmcnt(4)
    s_waitcnt lgkmcnt(12)
    v_mfma_f32_16x16x32_bf16 v[32:35], v[176:179], v[68:71], v[32:35]
    ds_read_b64_tr_b16 v[216:217], v16 offset:32768
    ds_read_b64_tr_b16 v[218:219], v16 offset:34816
    v_mfma_f32_16x16x32_bf16 v[36:39], v[180:183], v[68:71], v[36:39]
    ds_read_b64_tr_b16 v[220:221], v17 offset:32768
    v_mfma_f32_16x16x32_bf16 v[40:43], v[184:187], v[68:71], v[40:43]
    ds_read_b64_tr_b16 v[222:223], v17 offset:34816
    ds_read_b64_tr_b16 v[224:225], v14 offset:36864
    v_mfma_f32_16x16x32_bf16 v[44:47], v[188:191], v[68:71], v[44:47]
    ds_read_b64_tr_b16 v[226:227], v14 offset:38912
    s_waitcnt vmcnt(3)
    s_waitcnt lgkmcnt(10)
    v_mfma_f32_16x16x32_bf16 v[32:35], v[192:195], v[72:75], v[32:35]
    ds_read_b64_tr_b16 v[228:229], v15 offset:36864
    ds_read_b64_tr_b16 v[230:231], v15 offset:38912
    v_mfma_f32_16x16x32_bf16 v[36:39], v[196:199], v[72:75], v[36:39]
    ds_read_b64_tr_b16 v[232:233], v16 offset:36864
    v_mfma_f32_16x16x32_bf16 v[40:43], v[200:203], v[72:75], v[40:43]
    ds_read_b64_tr_b16 v[234:235], v16 offset:38912
    ds_read_b64_tr_b16 v[236:237], v17 offset:36864
    v_mfma_f32_16x16x32_bf16 v[44:47], v[204:207], v[72:75], v[44:47]
    ds_read_b64_tr_b16 v[238:239], v17 offset:38912
    s_waitcnt vmcnt(2)
    s_waitcnt lgkmcnt(8)
    v_mfma_f32_16x16x32_bf16 v[32:35], v[208:211], v[76:79], v[32:35]
    ds_read_b64_tr_b16 v[240:241], v10 offset:0
    ds_read_b64_tr_b16 v[242:243], v10 offset:2048
    v_mfma_f32_16x16x32_bf16 v[36:39], v[212:215], v[76:79], v[36:39]
    ds_read_b64_tr_b16 v[244:245], v11 offset:0
    v_mfma_f32_16x16x32_bf16 v[40:43], v[216:219], v[76:79], v[40:43]
    ds_read_b64_tr_b16 v[246:247], v11 offset:2048
    ds_read_b64_tr_b16 v[248:249], v12 offset:0
    v_mfma_f32_16x16x32_bf16 v[44:47], v[220:223], v[76:79], v[44:47]
    ds_read_b64_tr_b16 v[250:251], v12 offset:2048
    s_waitcnt vmcnt(1)
    s_waitcnt lgkmcnt(6)
    v_mfma_f32_16x16x32_bf16 v[32:35], v[224:227], v[80:83], v[32:35]
    ds_read_b64_tr_b16 v[252:253], v13 offset:0
    ds_read_b64_tr_b16 v[254:255], v13 offset:2048
    v_mfma_f32_16x16x32_bf16 v[36:39], v[228:231], v[80:83], v[36:39]
    v_mfma_f32_16x16x32_bf16 v[40:43], v[232:235], v[80:83], v[40:43]
    v_mfma_f32_16x16x32_bf16 v[44:47], v[236:239], v[80:83], v[44:47]
    s_waitcnt vmcnt(0)
    s_waitcnt lgkmcnt(0)
    v_mfma_f32_16x16x32_bf16 v[32:35], v[240:243], v[84:87], v[32:35]
    v_mfma_f32_16x16x32_bf16 v[36:39], v[244:247], v[84:87], v[36:39]
    v_mfma_f32_16x16x32_bf16 v[40:43], v[248:251], v[84:87], v[40:43]
    v_mfma_f32_16x16x32_bf16 v[44:47], v[252:255], v[84:87], v[44:47]
    s_cmp_eq_u32 s49, 0
    s_cbranch_scc0 L_addy
L_final:
    s_nop 2
    s_nop 0
    v_cvt_pk_bf16_f32 v24, v32, v33
    v_cvt_pk_bf16_f32 v25, v34, v35
    v_cvt_pk_bf16_f32 v26, v36, v37
    v_cvt_pk_bf16_f32 v27, v38, v39
    v_cvt_pk_bf16_f32 v28, v40, v41
    v_cvt_pk_bf16_f32 v29, v42, v43
    v_cvt_pk_bf16_f32 v30, v44, v45
    v_cvt_pk_bf16_f32 v31, v46, v47
    v_permlane16_swap_b32 v24, v26
    v_permlane16_swap_b32 v25, v27
    buffer_store_dwordx4 v[24:27], v18, s[24:27], 0 offen offset:0 nt
    v_permlane16_swap_b32 v28, v30
    v_permlane16_swap_b32 v29, v31
    buffer_store_dwordx4 v[28:31], v18, s[24:27], 0 offen offset:64 nt
    s_endpgm
L_xfar:
    buffer_store_dwordx4 v[224:227], v8, s[20:23], s7 offen sc1
    buffer_store_dwordx4 v[228:231], v8, s[20:23], s100 offen sc1
    s_branch L_xsent
L_xretry:
    s_sub_u32 s46, s46, 1
    s_cmp_eq_u32 s46, 0
    s_cbranch_scc1 L_xp_ok
    buffer_load_dwordx4 v[216:219], v8, s[20:23], s51 offen sc1
    buffer_load_dwordx4 v[220:223], v8, s[20:23], s50 offen offset:1024 sc1
    s_branch L_xp
L_ysig:
    v_mov_b32 v48, 116744
    v_mov_b32 v49, 1
    s_mov_b64 exec, 1
    ds_add_u32 v48, v49 offset:4
    s_mov_b64 exec, -1
    s_waitcnt lgkmcnt(0)
    s_branch L_ysig_ok
L_fretry:
    s_mov_b32 s46, 262144
L_fpoll:
    buffer_load_dword v1, v19, s[20:23], s52 offen sc1
    s_sub_u32 s46, s46, 1
    s_cmp_eq_u32 s46, 0
    s_waitcnt vmcnt(0)
    s_cbranch_scc1 L_fpoll_ok
    v_cmp_ne_u32_e64 vcc, s31, v1
    s_cmp_lg_u64 vcc, 0
    s_cbranch_scc1 L_fpoll
    s_branch L_fpoll_ok
L_addy:
    s_mov_b32 s46, 262144
L_yw:
    ds_read_b32 v1, v9 offset:2048
    s_waitcnt lgkmcnt(0)
    v_readfirstlane_b32 s47, v1
    s_cmp_eq_u32 s47, 0
    s_cbranch_scc0 L_yw_ok
    s_sub_u32 s46, s46, 1
    s_cmp_lg_u32 s46, 0
    s_cbranch_scc1 L_yw
L_yw_ok:
    s_lshl_b32 s47, s44, 4
    v_add_u32 v48, s47, v5
    v_lshlrev_b32 v49, 4, v6
    v_add_u32 v49, 117760, v49
    v_cmp_eq_u32_e64 vcc, s99, v48
    v_cmp_eq_u32 s[70:71], s98, v48
    v_add_u32 v50, 256, v49
    v_cndmask_b32 v49, v49, v50, vcc
    s_or_b64 vcc, vcc, s[70:71]
    ds_read_b128 v[52:55], v49 offset:0
    ds_read_b128 v[56:59], v49 offset:64
    ds_read_b128 v[60:63], v49 offset:128
    ds_read_b128 v[64:67], v49 offset:192
    s_mov_b64 exec, vcc
    s_waitcnt lgkmcnt(0)
    v_add_f32 v32, v32, v52
    v_add_f32 v33, v33, v53
    v_add_f32 v34, v34, v54
    v_add_f32 v35, v35, v55
    v_add_f32 v36, v36, v56
    v_add_f32 v37, v37, v57
    v_add_f32 v38, v38, v58
    v_add_f32 v39, v39, v59
    v_add_f32 v40, v40, v60
    v_add_f32 v41, v41, v61
    v_add_f32 v42, v42, v62
    v_add_f32 v43, v43, v63
    v_add_f32 v44, v44, v64
    v_add_f32 v45, v45, v65
    v_add_f32 v46, v46, v66
    v_add_f32_e64 v47, v47, v67
    s_mov_b64 exec, -1
    s_branch L_final
L_collect:
    s_barrier
    s_mov_b32 m0, 79872
    s_add_u32 s47, s61, -30720
    buffer_load_dwordx4 v4, s[16:19], s47 offen lds
    s_mov_b32 m0, 80896
    s_add_u32 s47, s61, -20480
    buffer_load_dwordx4 v4, s[16:19], s47 offen lds
    s_mov_b32 m0, 81920
    s_add_u32 s47, s61, -10240
    buffer_load_dwordx4 v4, s[16:19], s47 offen lds
    s_mov_b32 m0, 82944
    s_add_u32 s47, s61, 0
    s_nop 0
    buffer_load_dwordx4 v4, s[16:19], s47 offen lds
    s_mov_b32 m0, 83968
    s_add_u32 s47, s61, 10240
    buffer_load_dwordx4 v4, s[16:19], s47 offen lds
    s_mov_b32 m0, 84992
    s_add_u32 s47, s61, 20480
    buffer_load_dwordx4 v4, s[16:19], s47 offen lds
    s_mov_b32 m0, 86016
    s_add_u32 s47, s61, 30720
    buffer_load_dwordx4 v4, s[16:19], s47 offen lds
    s_mov_b32 m0, 87040
    s_add_u32 s47, s61, 40960
    buffer_load_dwordx4 v4, s[16:19], s47 offen lds
    s_mov_b32 m0, 88064
    s_add_u32 s47, s61, 51200
    buffer_load_dwordx4 v4, s[16:19], s47 offen lds
    s_mov_b32 m0, 89088
    s_add_u32 s47, s61, 61440
    buffer_load_dwordx4 v4, s[16:19], s47 offen lds
    s_mov_b32 m0, 90112
    s_add_u32 s47, s61, 71680
    buffer_load_dwordx4 v4, s[16:19], s47 offen lds
    s_mov_b32 m0, 91136
    s_add_u32 s47, s61, 81920
    buffer_load_dwordx4 v4, s[16:19], s47 offen lds
    s_mov_b32 m0, 92160
    s_add_u32 s47, s61, 92160
    buffer_load_dwordx4 v4, s[16:19], s47 offen lds
    s_mov_b32 m0, 93184
    s_add_u32 s47, s61, 102400
    buffer_load_dwordx4 v4, s[16:19], s47 offen lds
    s_mov_b32 m0, 94208
    s_add_u32 s47, s61, 112640
    buffer_load_dwordx4 v4, s[16:19], s47 offen lds
    s_mov_b32 m0, 95232
    s_add_u32 s47, s61, 122880
    buffer_load_dwordx4 v4, s[16:19], s47 offen lds
    s_mov_b32 m0, 96256
    s_add_u32 s47, s61, 133120
    buffer_load_dwordx4 v4, s[16:19], s47 offen lds
    s_mov_b32 m0, 97280
    s_add_u32 s47, s61, 143360
    buffer_load_dwordx4 v4, s[16:19], s47 offen lds
    s_mov_b32 m0, 98304
    s_add_u32 s47, s61, 153600
    buffer_load_dwordx4 v4, s[16:19], s47 offen lds
    s_mov_b32 m0, 99328
    s_add_u32 s47, s61, 163840
    buffer_load_dwordx4 v4, s[16:19], s47 offen lds
    s_mov_b32 m0, 100352
    s_add_u32 s47, s61, 174080
    buffer_load_dwordx4 v4, s[16:19], s47 offen lds
    s_mov_b32 m0, 101376
    s_add_u32 s47, s61, 184320
    buffer_load_dwordx4 v4, s[16:19], s47 offen lds
    s_mov_b32 m0, 102400
    s_add_u32 s47, s61, 194560
    buffer_load_dwordx4 v4, s[16:19], s47 offen lds
    s_mov_b32 m0, 103424
    s_add_u32 s47, s61, 204800
    buffer_load_dwordx4 v4, s[16:19], s47 offen lds
    s_mov_b32 m0, 104448
    s_add_u32 s47, s61, 215040
    buffer_load_dwordx4 v4, s[16:19], s47 offen lds
    s_mov_b32 m0, 105472
    s_add_u32 s47, s61, 225280
    buffer_load_dwordx4 v4, s[16:19], s47 offen lds
    s_mov_b32 m0, 106496
    s_add_u32 s47, s61, 235520
    buffer_load_dwordx4 v4, s[16:19], s47 offen lds
    s_mov_b32 m0, 107520
    s_add_u32 s47, s61, 245760
    buffer_load_dwordx4 v4, s[16:19], s47 offen lds
    s_mov_b32 m0, 108544
    s_add_u32 s47, s61, 256000
    buffer_load_dwordx4 v4, s[16:19], s47 offen lds
    s_mov_b32 m0, 109568
    s_add_u32 s47, s61, 266240
    buffer_load_dwordx4 v4, s[16:19], s47 offen lds
    s_mov_b32 m0, 110592
    s_add_u32 s47, s61, 276480
    buffer_load_dwordx4 v4, s[16:19], s47 offen lds
    s_mov_b32 m0, 111616
    s_add_u32 s47, s61, 286720
    buffer_load_dwordx4 v4, s[16:19], s47 offen lds
    s_mov_b32 m0, 112640
    s_add_u32 s47, s61, 296960
    buffer_load_dwordx4 v4, s[16:19], s47 offen lds
    s_mov_b32 m0, 113664
    s_add_u32 s47, s61, 307200
    buffer_load_dwordx4 v4, s[16:19], s47 offen lds
    s_mov_b32 m0, 114688
    s_add_u32 s47, s61, 317440
    buffer_load_dwordx4 v4, s[16:19], s47 offen lds
    s_mov_b32 m0, 115712
    s_add_u32 s47, s61, 327680
    buffer_load_dwordx4 v4, s[16:19], s47 offen lds
    s_mov_b32 m0, 34816
    s_add_u32 s47, s61, 337920
    buffer_load_dwordx4 v4, s[16:19], s47 offen lds
    s_mov_b32 m0, 35840
    s_add_u32 s47, s61, 348160
    buffer_load_dwordx4 v4, s[16:19], s47 offen lds
    s_mov_b32 m0, 36864
    s_add_u32 s47, s61, 358400
    buffer_load_dwordx4 v4, s[16:19], s47 offen lds
    s_mov_b32 m0, 37888
    s_add_u32 s47, s61, 368640
    buffer_load_dwordx4 v4, s[16:19], s47 offen lds
    s_lshl_b32 s47, s34, 4
    v_add_u32 v54, s47, v5
    v_mul_u32_u24 v55, 3277, v54
    v_lshrrev_b32_e64 v55, 16, v55
    v_mul_u32_u24 v55, 320, v55
    v_lshl_add_u32 v54, v54, 4, v55
    v_and_b32_e64 v55, 1, v6
    v_mul_u32_u24 v55, 320, v55
    v_lshrrev_b32_e64 v56, 1, v6
    v_mul_u32_u24 v56, 5120, v56
    v_add3_u32 v54, v54, v55, v56
    v_cmp_gt_u32 s[70:71], 2, v6
    v_mov_b32 v55, 2130706432
    s_nop 0
    v_cndmask_b32 v55, v55, v54, s[70:71]
    s_mov_b32 s56, 65536
    v_and_b32 v56, 1, v6
    v_cmp_eq_u32 vcc, 0, v56
    v_lshlrev_b32 v50, 8, v56
    v_lshl_add_u32 v50, v5, 4, v50
    v_add_u32 v50, 117760, v50
    v_cndmask_b32_e64 v56, v53, v52, vcc
    v_and_b32 v56, 0xfffff800, v56
    v_not_b32 v57, v56
    v_ashrrev_i32 v57, 31, v57
    v_or_b32 v57, 0x80000000, v57
    v_xor_b32_e64 v56, v56, v57
    v_mul_f32 v56, 0xbfb8aa3b, v56
    v_exp_f32 v56, v56
    s_nop 0
    v_add_f32 v56, 1.0, v56
    v_rcp_f32 v51, v56
    s_and_b32 s50, s50, s51
    s_mov_b32 s52, 1
    s_bfe_u32 s47, s31, 524288
    v_mov_b32_e64 v60, s47
    s_bfe_u32 s47, s31, 524296
    v_mov_b32_e64 v61, s47
    s_bfe_u32 s47, s31, 524304
    v_mov_b32_e64 v62, s47
    s_bfe_u32 s47, s31, 524312
    v_mov_b32_e64 v63, s47
    s_add_u32 s47, s4, 167936
    s_cmp_ge_u32 s34, 5
    s_cselect_b32 s48, 0, 76800
    s_add_u32 s48, s48, s45
    s_add_u32 s48, s48, 167936
    s_add_u32 s63, s48, 0
    s_add_u32 s64, s48, 15360
    s_add_u32 s65, s48, 30720
    s_add_u32 s66, s48, 46080
    s_add_u32 s67, s48, 61440
    v_mov_b32 v58, 1
    v_mov_b32 v9, 116744
    s_cmp_eq_u32 s50, -1
    s_cbranch_scc1 L_noy
    s_mov_b32 s46, 262144
L_cs:
    ds_read_b32 v59, v9 offset:4
    s_waitcnt lgkmcnt(0)
    v_readfirstlane_b32 s49, v59
    s_cmp_lg_u32 s49, 7
    s_cbranch_scc0 L_cs_ok
    s_sleep 1
    s_sub_u32 s46, s46, 1
    s_cmp_lg_u32 s46, 0
    s_cbranch_scc1 L_cs
L_cs_ok:
    s_add_u32 s47, s56, 0
    s_nop 0
    buffer_load_dwordx4 v[64:67], v54, s[20:23], s47 offen sc1
    s_add_u32 s47, s56, 10240
    buffer_load_dwordx4 v[68:71], v54, s[20:23], s47 offen sc1
    s_add_u32 s47, s56, 20480
    buffer_load_dwordx4 v[72:75], v54, s[20:23], s47 offen sc1
    s_add_u32 s47, s56, 30720
    buffer_load_dwordx4 v[76:79], v54, s[20:23], s47 offen sc1
    s_add_u32 s47, s56, 40960
    buffer_load_dwordx4 v[80:83], v54, s[20:23], s47 offen sc1
    s_add_u32 s47, s56, 51200
    buffer_load_dwordx4 v[84:87], v54, s[20:23], s47 offen sc1
    s_add_u32 s47, s56, 61440
    buffer_load_dwordx4 v[88:91], v54, s[20:23], s47 offen sc1
    s_add_u32 s47, s56, 71680
    buffer_load_dwordx4 v[92:95], v54, s[20:23], s47 offen sc1
    s_add_u32 s47, s56, 81920
    buffer_load_dwordx4 v[96:99], v54, s[20:23], s47 offen sc1
    s_add_u32 s47, s56, 92160
    buffer_load_dwordx4 v[100:103], v54, s[20:23], s47 offen sc1
    s_add_u32 s47, s56, 102400
    buffer_load_dwordx4 v[104:107], v54, s[20:23], s47 offen sc1
    s_add_u32 s47, s56, 112640
    buffer_load_dwordx4 v[108:111], v54, s[20:23], s47 offen sc1
    s_add_u32 s47, s56, 122880
    buffer_load_dwordx4 v[112:115], v54, s[20:23], s47 offen sc1
    s_add_u32 s47, s56, 133120
    buffer_load_dwordx4 v[116:119], v55, s[20:23], s47 offen sc1
L_noy:
    s_add_u32 s47, s4, 167936
    s_mov_b32 s46, 262144
L_cw:
    ds_read_b32 v59, v9
    s_waitcnt lgkmcnt(0)
    v_readfirstlane_b32 s49, v59
    s_cmp_lg_u32 s49, 7
    s_cbranch_scc0 L_cw_ok
    s_sleep 1
    s_sub_u32 s46, s46, 1
    s_cmp_lg_u32 s46, 0
    s_cbranch_scc1 L_cw
L_cw_ok:
    s_atomic_add s52, s[20:21], s47 glc
    s_mov_b32 s51, 0
    s_cmp_eq_u32 s50, -1
    s_cbranch_scc0 L_ychk
L_rp:
    s_nop 0
    s_mov_b32 s46, 262144
L_rpoll:
    s_load_dword s58, s[20:21], s63 glc
    s_load_dword s59, s[20:21], s64 glc
    s_load_dword s60, s[20:21], s65 glc
    s_load_dword s61, s[20:21], s66 glc
    s_load_dword s62, s[20:21], s67 glc
    s_waitcnt lgkmcnt(0)
    s_xor_b32 s58, s58, s31
    s_xor_b32 s59, s59, s31
    s_xor_b32 s60, s60, s31
    s_xor_b32 s61, s61, s31
    s_xor_b32 s62, s62, s31
    s_or_b32 s58, s58, s59
    s_or_b32 s58, s58, s60
    s_or_b32 s58, s58, s61
    s_or_b32 s58, s58, s62
    s_cbranch_scc0 L_rpoll_ok
    s_sub_u32 s46, s46, 1
    s_cmp_lg_u32 s46, 0
    s_cbranch_scc1 L_rpoll
L_rpoll_ok:
    s_waitcnt vmcnt(0)
    s_barrier
    s_cmp_eq_u32 s50, -1
    s_cbranch_scc1 L_fin
    s_mov_b32 s51, 1
    s_mov_b32 s49, 262144
L_yagain:
    s_add_u32 s47, s56, 0
    buffer_load_dwordx4 v[64:67], v54, s[20:23], s47 offen sc1
    s_add_u32 s47, s56, 10240
    buffer_load_dwordx4 v[68:71], v54, s[20:23], s47 offen sc1
    s_add_u32 s47, s56, 20480
    buffer_load_dwordx4 v[72:75], v54, s[20:23], s47 offen sc1
    s_add_u32 s47, s56, 30720
    buffer_load_dwordx4 v[76:79], v54, s[20:23], s47 offen sc1
    s_add_u32 s47, s56, 40960
    buffer_load_dwordx4 v[80:83], v54, s[20:23], s47 offen sc1
    s_add_u32 s47, s56, 51200
    buffer_load_dwordx4 v[84:87], v54, s[20:23], s47 offen sc1
    s_add_u32 s47, s56, 61440
    buffer_load_dwordx4 v[88:91], v54, s[20:23], s47 offen sc1
    s_add_u32 s47, s56, 71680
    buffer_load_dwordx4 v[92:95], v54, s[20:23], s47 offen sc1
    s_add_u32 s47, s56, 81920
    buffer_load_dwordx4 v[96:99], v54, s[20:23], s47 offen sc1
    s_add_u32 s47, s56, 92160
    buffer_load_dwordx4 v[100:103], v54, s[20:23], s47 offen sc1
    s_add_u32 s47, s56, 102400
    buffer_load_dwordx4 v[104:107], v54, s[20:23], s47 offen sc1
    s_add_u32 s47, s56, 112640
    buffer_load_dwordx4 v[108:111], v54, s[20:23], s47 offen sc1
    s_add_u32 s47, s56, 122880
    buffer_load_dwordx4 v[112:115], v54, s[20:23], s47 offen sc1
    s_add_u32 s47, s56, 133120
    buffer_load_dwordx4 v[116:119], v55, s[20:23], s47 offen sc1
L_ychk:
    s_waitcnt vmcnt(0)
    v_cndmask_b32 v116, v60, v116, s[70:71]
    v_cndmask_b32 v117, v61, v117, s[70:71]
    v_cndmask_b32 v118, v62, v118, s[70:71]
    v_cndmask_b32 v119, v63, v119, s[70:71]
    v_xor_b32 v64, v60, v64
    v_xor_b32 v65, v61, v65
    v_xor_b32 v66, v62, v66
    v_xor_b32_e64 v67, v63, v67
    v_or3_b32 v57, v64, v65, v66
    v_or_b32 v57, v57, v67
    v_xor_b32 v68, v60, v68
    v_xor_b32 v69, v61, v69
    v_xor_b32 v70, v62, v70
    v_xor_b32_e64 v71, v63, v71
    v_or3_b32 v57, v57, v68, v69
    v_or3_b32 v57, v57, v70, v71
    v_add_f32 v64, v64, v68
    v_add_f32 v65, v65, v69
    v_add_f32 v66, v66, v70
    v_add_f32 v67, v67, v71
    v_xor_b32 v72, v60, v72
    v_xor_b32 v73, v61, v73
    v_xor_b32 v74, v62, v74
    v_xor_b32 v75, v63, v75
    v_or3_b32 v57, v57, v72, v73
    v_or3_b32 v57, v57, v74, v75
    v_add_f32 v64, v64, v72
    v_add_f32 v65, v65, v73
    v_add_f32 v66, v66, v74
    v_add_f32 v67, v67, v75
    v_xor_b32 v76, v60, v76
    v_xor_b32 v77, v61, v77
    v_xor_b32 v78, v62, v78
    v_xor_b32 v79, v63, v79
    v_or3_b32 v57, v57, v76, v77
    v_or3_b32 v57, v57, v78, v79
    v_add_f32 v64, v64, v76
    v_add_f32 v65, v65, v77
    v_add_f32 v66, v66, v78
    v_add_f32 v67, v67, v79
    v_xor_b32 v80, v60, v80
    v_xor_b32 v81, v61, v81
    v_xor_b32 v82, v62, v82
    v_xor_b32 v83, v63, v83
    v_or3_b32 v57, v57, v80, v81
    v_or3_b32 v57, v57, v82, v83
    v_add_f32 v64, v64, v80
    v_add_f32 v65, v65, v81
    v_add_f32 v66, v66, v82
    v_add_f32 v67, v67, v83
    v_xor_b32 v84, v60, v84
    v_xor_b32 v85, v61, v85
    v_xor_b32 v86, v62, v86
    v_xor_b32 v87, v63, v87
    v_or3_b32 v57, v57, v84, v85
    v_or3_b32 v57, v57, v86, v87
    v_add_f32 v64, v64, v84
    v_add_f32 v65, v65, v85
    v_add_f32 v66, v66, v86
    v_add_f32 v67, v67, v87
    v_xor_b32 v88, v60, v88
    v_xor_b32 v89, v61, v89
    v_xor_b32 v90, v62, v90
    v_xor_b32 v91, v63, v91
    v_or3_b32 v57, v57, v88, v89
    v_or3_b32 v57, v57, v90, v91
    v_add_f32 v64, v64, v88
    v_add_f32 v65, v65, v89
    v_add_f32 v66, v66, v90
    v_add_f32 v67, v67, v91
    v_xor_b32 v92, v60, v92
    v_xor_b32 v93, v61, v93
    v_xor_b32 v94, v62, v94
    v_xor_b32 v95, v63, v95
    v_or3_b32 v57, v57, v92, v93
    v_or3_b32 v57, v57, v94, v95
    v_add_f32 v64, v64, v92
    v_add_f32 v65, v65, v93
    v_add_f32 v66, v66, v94
    v_add_f32 v67, v67, v95
    v_xor_b32 v96, v60, v96
    v_xor_b32 v97, v61, v97
    v_xor_b32 v98, v62, v98
    v_xor_b32 v99, v63, v99
    v_or3_b32 v57, v57, v96, v97
    v_or3_b32 v57, v57, v98, v99
    v_add_f32 v64, v64, v96
    v_add_f32 v65, v65, v97
    v_add_f32 v66, v66, v98
    v_add_f32 v67, v67, v99
    v_xor_b32 v100, v60, v100
    v_xor_b32 v101, v61, v101
    v_xor_b32 v102, v62, v102
    v_xor_b32 v103, v63, v103
    v_or3_b32 v57, v57, v100, v101
    v_or3_b32 v57, v57, v102, v103
    v_add_f32 v64, v64, v100
    v_add_f32 v65, v65, v101
    v_add_f32 v66, v66, v102
    v_add_f32 v67, v67, v103
    v_xor_b32 v104, v60, v104
    v_xor_b32 v105, v61, v105
    v_xor_b32 v106, v62, v106
    v_xor_b32 v107, v63, v107
    v_or3_b32 v57, v57, v104, v105
    v_or3_b32 v57, v57, v106, v107
    v_add_f32 v64, v64, v104
    v_add_f32 v65, v65, v105
    v_add_f32 v66, v66, v106
    v_add_f32 v67, v67, v107
    v_xor_b32 v108, v60, v108
    v_xor_b32 v109, v61, v109
    v_xor_b32 v110, v62, v110
    v_xor_b32 v111, v63, v111
    v_or3_b32 v57, v57, v108, v109
    v_or3_b32 v57, v57, v110, v111
    v_add_f32 v64, v64, v108
    v_add_f32 v65, v65, v109
    v_add_f32 v66, v66, v110
    v_add_f32 v67, v67, v111
    v_xor_b32 v112, v60, v112
    v_xor_b32 v113, v61, v113
    v_xor_b32 v114, v62, v114
    v_xor_b32 v115, v63, v115
    v_or3_b32 v57, v57, v112, v113
    v_or3_b32 v57, v57, v114, v115
    v_add_f32 v64, v64, v112
    v_add_f32 v65, v65, v113
    v_add_f32 v66, v66, v114
    v_add_f32 v67, v67, v115
    v_xor_b32 v116, v60, v116
    v_xor_b32 v117, v61, v117
    v_xor_b32 v118, v62, v118
    v_xor_b32 v119, v63, v119
    v_or3_b32 v57, v57, v116, v117
    v_or3_b32 v57, v57, v118, v119
    v_add_f32 v64, v64, v116
    v_add_f32 v65, v65, v117
    v_add_f32 v66, v66, v118
    v_add_f32 v67, v67, v119
    v_and_b32 v57, 0xff, v57
    v_cmp_ne_u32 vcc, 0, v57
    s_cmp_lg_u64 vcc, 0
    s_cbranch_scc0 L_yok
    s_cmp_eq_u32 s51, 0
    s_cbranch_scc1 L_rp
    s_sub_u32 s49, s49, 1
    s_cmp_lg_u32 s49, 0
    s_sleep 4
    s_cbranch_scc1 L_yagain
L_yok:
    v_mov_b32 v68, v64
    v_mov_b32 v69, v65
    v_mov_b32 v70, v66
    v_mov_b32 v71, v67
    v_permlane32_swap_b32 v68, v64
    v_permlane32_swap_b32 v69, v65
    v_permlane32_swap_b32 v70, v66
    v_permlane32_swap_b32 v71, v67
    v_add_f32 v64, v64, v68
    v_add_f32 v65, v65, v69
    v_add_f32 v66, v66, v70
    v_add_f32 v67, v67, v71
    v_mul_f32 v64, v64, v51
    v_mul_f32 v65, v65, v51
    v_mul_f32 v66, v66, v51
    v_mul_f32_e64 v67, v67, v51
    ds_write_b128 v50, v[64:67]
    ds_write_b32 v9, v58 offset:2048
    s_mov_b32 s50, -1
    s_cmp_eq_u32 s51, 0
    s_cbranch_scc1 L_rp
    s_endpgm
L_aux:
    s_load_dwordx2 s[20:21], s[0:1], 80
    s_load_dwordx2 s[16:17], s[0:1], 16
    s_mov_b32 s10, 2621440
    s_mov_b32 s11, 0x20000
    s_mov_b32 s22, 268435456
    s_mov_b32 s23, 0x20000
    s_mov_b32 s18, 819200
    s_mov_b32 s19, 0x20000
    v_and_b32 v0, 63, v0
    v_lshrrev_b32 v5, 3, v0
    v_and_b32 v6, 7, v0
    v_and_b32 v1, 1, v1
    v_lshlrev_b32 v1, 2, v1
    v_xor_b32 v1, v1, v6
    v_and_b32 v7, 2, v5
    v_xor_b32_e64 v9, v7, v1
    s_lshr_b32 s32, s28, 1
    s_sub_u32 s47, s29, 25
    s_lshl_b32 s33, s47, 1
    s_and_b32 s48, s28, 1
    s_add_u32 s33, s33, s48
    v_mul_u32_u24 v4, 1280, v5
    v_lshl_add_u32 v4, v9, 4, v4
    v_and_b32 v5, 15, v0
    v_lshrrev_b32 v6, 4, v0
    s_cmp_ge_u32 s33, 7
    s_cbranch_scc1 L_moe
    s_load_dwordx2 s[60:61], s[0:1], 32
    s_mov_b32 s62, 1280
    s_mov_b32 s63, 0x20000
    s_load_dwordx2 s[64:65], s[0:1], 56
    s_mov_b32 s66, 2211840
    s_mov_b32 s67, 0x20000
    s_lshr_b32 s34, s32, 1
    s_mul_i32 s35, s33, 76
    s_lshl_b32 s47, s30, 2
    s_add_u32 s35, s35, s47
    s_and_b32 s48, s32, 1
    s_lshl_b32 s48, s48, 9
    v_mov_b32 v15, 2130706432
    v_lshlrev_b32 v16, 4, v5
    s_add_u32 s47, s35, 0
    v_add_u32 v7, s47, v6
    s_movk_i32 s47, 512
    v_cmp_gt_u32 vcc, s47, v7
    v_add_u32_e64 v7, s48, v7
    v_lshl_add_u32 v7, v7, 1, s34
    v_cndmask_b32_e64 v10, -1, v7, vcc
    v_mul_u32_u24 v8, 1280, v7
    v_add_u32 v8, v8, v16
    v_cndmask_b32 v100, v15, v8, vcc
    s_add_u32 s47, s35, 32
    v_add_u32 v7, s47, v6
    s_movk_i32 s47, 512
    v_cmp_gt_u32 vcc, s47, v7
    v_add_u32_e64 v7, s48, v7
    v_lshl_add_u32 v7, v7, 1, s34
    v_cndmask_b32_e64 v11, -1, v7, vcc
    v_mul_u32_u24 v8, 1280, v7
    v_add_u32 v8, v8, v16
    v_cndmask_b32 v101, v15, v8, vcc
    s_add_u32 s47, s35, 64
    v_add_u32 v7, s47, v6
    s_movk_i32 s47, 512
    s_cmp_lt_u32 s30, 3
    s_cselect_b32 s47, s47, 0
    v_cmp_gt_u32 vcc, s47, v7
    v_add_u32_e64 v7, s48, v7
    v_lshl_add_u32 v7, v7, 1, s34
    v_cndmask_b32_e64 v12, -1, v7, vcc
    v_mul_u32_u24 v8, 1280, v7
    v_add_u32 v8, v8, v16
    v_cndmask_b32_e64 v102, v15, v8, vcc
    s_waitcnt lgkmcnt(0)
    s_load_dword s31, s[20:21], 0
    buffer_load_dwordx4 v[20:23], v16, s[60:63], 0 offen offset:0
    buffer_load_dwordx4 v[24:27], v16, s[60:63], 0 offen offset:256
    buffer_load_dwordx4 v[28:31], v16, s[60:63], 0 offen offset:512
    buffer_load_dwordx4 v[32:35], v16, s[60:63], 0 offen offset:768
    buffer_load_dwordx4 v[36:39], v16, s[60:63], 0 offen offset:1024
    buffer_load_dwordx4 v[40:43], v100, s[8:11], 0 offen offset:0
    buffer_load_dwordx4 v[44:47], v100, s[8:11], 0 offen offset:256
    buffer_load_dwordx4 v[48:51], v100, s[8:11], 0 offen offset:512
    buffer_load_dwordx4 v[52:55], v100, s[8:11], 0 offen offset:768
    buffer_load_dwordx4 v[56:59], v100, s[8:11], 0 offen offset:1024
    v_mov_b32 v17, 0x3f803f80
    v_mov_b32 v18, 0
    v_mov_b32 v110, 0
    v_mov_b32 v111, 0
    s_lshl_b32 s47, s34, 14
    s_add_u32 s50, s47, 8192
    v_cmp_eq_u32 s[70:71], 0, v5
    s_waitcnt vmcnt(5)
    s_nop 0
    v_dot2_f32_bf16 v18, v20, v17, v18
    v_dot2_f32_bf16 v18, v21, v17, v18
    v_dot2_f32_bf16 v18, v22, v17, v18
    v_dot2_f32_bf16 v18, v23, v17, v18
    v_dot2_f32_bf16 v18, v24, v17, v18
    v_dot2_f32_bf16 v18, v25, v17, v18
    v_dot2_f32_bf16 v18, v26, v17, v18
    v_dot2_f32_bf16 v18, v27, v17, v18
    v_dot2_f32_bf16 v18, v28, v17, v18
    v_dot2_f32_bf16 v18, v29, v17, v18
    v_dot2_f32_bf16 v18, v30, v17, v18
    v_dot2_f32_bf16 v18, v31, v17, v18
    v_dot2_f32_bf16 v18, v32, v17, v18
    v_dot2_f32_bf16 v18, v33, v17, v18
    v_dot2_f32_bf16 v18, v34, v17, v18
    v_dot2_f32_bf16 v18, v35, v17, v18
    v_dot2_f32_bf16 v18, v36, v17, v18
    v_dot2_f32_bf16 v18, v37, v17, v18
    v_dot2_f32_bf16 v18, v38, v17, v18
    v_dot2_f32_bf16 v18, v39, v17, v18
    s_nop 2
    v_add_f32_dpp v18, v18, v18 row_ror:8 row_mask:0xf bank_mask:0xf
    s_nop 1
    v_add_f32_dpp v18, v18, v18 row_ror:4 row_mask:0xf bank_mask:0xf
    s_nop 1
    v_add_f32_dpp v18, v18, v18 row_ror:2 row_mask:0xf bank_mask:0xf
    s_nop 1
    v_add_f32_dpp v18, v18, v18 row_ror:1 row_mask:0xf bank_mask:0xf
    s_waitcnt lgkmcnt(0)
    s_add_u32 s31, s31, 117768961
    s_waitcnt vmcnt(3)
    buffer_load_dwordx4 v[60:63], v101, s[8:11], 0 offen offset:0
    buffer_load_dwordx4 v[64:67], v101, s[8:11], 0 offen offset:256
    buffer_load_dwordx4 v[68:71], v101, s[8:11], 0 offen offset:512
    buffer_load_dwordx4 v[72:75], v101, s[8:11], 0 offen offset:768
    buffer_load_dwordx4 v[76:79], v101, s[8:11], 0 offen offset:1024
    s_waitcnt vmcnt(5)
    v_mov_b32 v104, 0
    v_mov_b32 v105, 0
    v_mov_b32 v106, 0
    v_dot2_f32_bf16 v104, v40, v17, v104
    v_dot2_f32_bf16 v105, v40, v40, v105
    v_dot2_f32_bf16 v106, v40, v20, v106
    v_dot2_f32_bf16 v104, v41, v17, v104
    v_dot2_f32_bf16 v105, v41, v41, v105
    v_dot2_f32_bf16 v106, v41, v21, v106
    v_dot2_f32_bf16 v104, v42, v17, v104
    v_dot2_f32_bf16 v105, v42, v42, v105
    v_dot2_f32_bf16 v106, v42, v22, v106
    v_dot2_f32_bf16 v104, v43, v17, v104
    v_dot2_f32_bf16 v105, v43, v43, v105
    v_dot2_f32_bf16 v106, v43, v23, v106
    v_dot2_f32_bf16 v104, v44, v17, v104
    v_dot2_f32_bf16 v105, v44, v44, v105
    v_dot2_f32_bf16 v106, v44, v24, v106
    v_dot2_f32_bf16 v104, v45, v17, v104
    v_dot2_f32_bf16 v105, v45, v45, v105
    v_dot2_f32_bf16 v106, v45, v25, v106
    v_dot2_f32_bf16 v104, v46, v17, v104
    v_dot2_f32_bf16 v105, v46, v46, v105
    v_dot2_f32_bf16 v106, v46, v26, v106
    v_dot2_f32_bf16 v104, v47, v17, v104
    v_dot2_f32_bf16 v105, v47, v47, v105
    v_dot2_f32_bf16 v106, v47, v27, v106
    v_dot2_f32_bf16 v104, v48, v17, v104
    v_dot2_f32_bf16 v105, v48, v48, v105
    v_dot2_f32_bf16 v106, v48, v28, v106
    v_dot2_f32_bf16 v104, v49, v17, v104
    v_dot2_f32_bf16 v105, v49, v49, v105
    v_dot2_f32_bf16 v106, v49, v29, v106
    v_dot2_f32_bf16 v104, v50, v17, v104
    v_dot2_f32_bf16 v105, v50, v50, v105
    v_dot2_f32_bf16 v106, v50, v30, v106
    v_dot2_f32_bf16 v104, v51, v17, v104
    v_dot2_f32_bf16 v105, v51, v51, v105
    v_dot2_f32_bf16 v106, v51, v31, v106
    v_dot2_f32_bf16 v104, v52, v17, v104
    v_dot2_f32_bf16 v105, v52, v52, v105
    v_dot2_f32_bf16 v106, v52, v32, v106
    v_dot2_f32_bf16 v104, v53, v17, v104
    v_dot2_f32_bf16 v105, v53, v53, v105
    v_dot2_f32_bf16 v106, v53, v33, v106
    v_dot2_f32_bf16 v104, v54, v17, v104
    v_dot2_f32_bf16 v105, v54, v54, v105
    v_dot2_f32_bf16 v106, v54, v34, v106
    v_dot2_f32_bf16 v104, v55, v17, v104
    v_dot2_f32_bf16 v105, v55, v55, v105
    v_dot2_f32_bf16 v106, v55, v35, v106
    v_dot2_f32_bf16 v104, v56, v17, v104
    v_dot2_f32_bf16 v105, v56, v56, v105
    v_dot2_f32_bf16 v106, v56, v36, v106
    v_dot2_f32_bf16 v104, v57, v17, v104
    v_dot2_f32_bf16 v105, v57, v57, v105
    v_dot2_f32_bf16 v106, v57, v37, v106
    v_dot2_f32_bf16 v104, v58, v17, v104
    v_dot2_f32_bf16 v105, v58, v58, v105
    v_dot2_f32_bf16 v106, v58, v38, v106
    v_dot2_f32_bf16 v104, v59, v17, v104
    v_dot2_f32_bf16 v105, v59, v59, v105
    v_dot2_f32_bf16 v106, v59, v39, v106
    s_nop 0
    s_nop 0
    v_add_f32_dpp v104, v104, v104 row_ror:8 row_mask:0xf bank_mask:0xf
    v_add_f32_dpp v105, v105, v105 row_ror:8 row_mask:0xf bank_mask:0xf
    v_add_f32_dpp v106, v106, v106 row_ror:8 row_mask:0xf bank_mask:0xf
    v_add_f32_dpp v104, v104, v104 row_ror:4 row_mask:0xf bank_mask:0xf
    v_add_f32_dpp v105, v105, v105 row_ror:4 row_mask:0xf bank_mask:0xf
    v_add_f32_dpp v106, v106, v106 row_ror:4 row_mask:0xf bank_mask:0xf
    v_add_f32_dpp v104, v104, v104 row_ror:2 row_mask:0xf bank_mask:0xf
    v_add_f32_dpp v105, v105, v105 row_ror:2 row_mask:0xf bank_mask:0xf
    v_add_f32_dpp v106, v106, v106 row_ror:2 row_mask:0xf bank_mask:0xf
    v_add_f32_dpp v104, v104, v104 row_ror:1 row_mask:0xf bank_mask:0xf
    v_add_f32_dpp v105, v105, v105 row_ror:1 row_mask:0xf bank_mask:0xf
    v_add_f32_dpp v106, v106, v106 row_ror:1 row_mask:0xf bank_mask:0xf
    v_mul_f32 v104, 0x3acccccd, v104
    v_mul_f32 v105, 0x3acccccd, v105
    v_fma_f32 v105, -v104, v104, v105
    v_max_f32_e64 v105, 0, v105
    v_cvt_pk_bf16_f32 v104, v104, v104
    v_lshlrev_b32_e64 v104, 16, v104
    v_cvt_pk_bf16_f32 v105, v105, v105
    v_lshlrev_b32_e64 v105, 16, v105
    v_add_f32 v105, 0x3727c5ac, v105
    v_cvt_pk_bf16_f32 v105, v105, v105
    v_lshlrev_b32 v105, 16, v105
    v_sqrt_f32 v105, v105
    v_sub_f32_e64 v112, 0, v104
    v_cvt_pk_bf16_f32 v105, v105, v105
    v_lshlrev_b32 v105, 16, v105
    v_rcp_f32 v113, v105
    v_fma_f32 v106, v112, v18, v106
    v_mul_f32 v106, v106, v113
    v_ashrrev_i32 v107, 31, v106
    v_or_b32 v107, 0x80000000, v107
    v_xor_b32 v106, v106, v107
    v_cmp_ne_u32 vcc, -1, v10
    v_and_b32 v106, 0xfffff800, v106
    v_or_b32 v114, v106, v10
    v_cndmask_b32 v114, 0, v114, vcc
    v_mov_b32 v115, s31
    s_and_b64 vcc, vcc, s[70:71]
    v_lshrrev_b32 v107, 1, v10
    v_lshlrev_b32 v107, 4, v107
    v_cndmask_b32_e64 v107, v15, v107, vcc
    buffer_store_dwordx4 v[112:115], v107, s[20:23], s50 offen sc1
    v_min_u32 v108, v110, v114
    v_max_u32 v110, v110, v114
    v_max_u32 v111, v111, v108
    s_waitcnt vmcnt(4)
    buffer_load_dwordx4 v[80:83], v102, s[8:11], 0 offen offset:0
    buffer_load_dwordx4 v[84:87], v102, s[8:11], 0 offen offset:256
    buffer_load_dwordx4 v[88:91], v102, s[8:11], 0 offen offset:512
    buffer_load_dwordx4 v[92:95], v102, s[8:11], 0 offen offset:768
    buffer_load_dwordx4 v[96:99], v102, s[8:11], 0 offen offset:1024
    s_waitcnt vmcnt(6)
    v_mov_b32 v104, 0
    v_mov_b32 v105, 0
    v_mov_b32 v106, 0
    v_dot2_f32_bf16 v104, v60, v17, v104
    v_dot2_f32_bf16 v105, v60, v60, v105
    v_dot2_f32_bf16 v106, v60, v20, v106
    v_dot2_f32_bf16 v104, v61, v17, v104
    v_dot2_f32_bf16 v105, v61, v61, v105
    v_dot2_f32_bf16 v106, v61, v21, v106
    v_dot2_f32_bf16 v104, v62, v17, v104
    v_dot2_f32_bf16 v105, v62, v62, v105
    v_dot2_f32_bf16 v106, v62, v22, v106
    v_dot2_f32_bf16 v104, v63, v17, v104
    v_dot2_f32_bf16 v105, v63, v63, v105
    v_dot2_f32_bf16 v106, v63, v23, v106
    v_dot2_f32_bf16 v104, v64, v17, v104
    v_dot2_f32_bf16 v105, v64, v64, v105
    v_dot2_f32_bf16 v106, v64, v24, v106
    v_dot2_f32_bf16 v104, v65, v17, v104
    v_dot2_f32_bf16 v105, v65, v65, v105
    v_dot2_f32_bf16 v106, v65, v25, v106
    v_dot2_f32_bf16 v104, v66, v17, v104
    v_dot2_f32_bf16 v105, v66, v66, v105
    v_dot2_f32_bf16 v106, v66, v26, v106
    v_dot2_f32_bf16 v104, v67, v17, v104
    v_dot2_f32_bf16 v105, v67, v67, v105
    v_dot2_f32_bf16 v106, v67, v27, v106
    v_dot2_f32_bf16 v104, v68, v17, v104
    v_dot2_f32_bf16 v105, v68, v68, v105
    v_dot2_f32_bf16 v106, v68, v28, v106
    v_dot2_f32_bf16 v104, v69, v17, v104
    v_dot2_f32_bf16 v105, v69, v69, v105
    v_dot2_f32_bf16 v106, v69, v29, v106
    v_dot2_f32_bf16 v104, v70, v17, v104
    v_dot2_f32_bf16 v105, v70, v70, v105
    v_dot2_f32_bf16 v106, v70, v30, v106
    v_dot2_f32_bf16 v104, v71, v17, v104
    v_dot2_f32_bf16 v105, v71, v71, v105
    v_dot2_f32_bf16 v106, v71, v31, v106
    v_dot2_f32_bf16 v104, v72, v17, v104
    v_dot2_f32_bf16 v105, v72, v72, v105
    v_dot2_f32_bf16 v106, v72, v32, v106
    v_dot2_f32_bf16 v104, v73, v17, v104
    v_dot2_f32_bf16 v105, v73, v73, v105
    v_dot2_f32_bf16 v106, v73, v33, v106
    v_dot2_f32_bf16 v104, v74, v17, v104
    v_dot2_f32_bf16 v105, v74, v74, v105
    v_dot2_f32_bf16 v106, v74, v34, v106
    v_dot2_f32_bf16 v104, v75, v17, v104
    v_dot2_f32_bf16 v105, v75, v75, v105
    v_dot2_f32_bf16 v106, v75, v35, v106
    v_dot2_f32_bf16 v104, v76, v17, v104
    v_dot2_f32_bf16 v105, v76, v76, v105
    v_dot2_f32_bf16 v106, v76, v36, v106
    v_dot2_f32_bf16 v104, v77, v17, v104
    v_dot2_f32_bf16 v105, v77, v77, v105
    v_dot2_f32_bf16 v106, v77, v37, v106
    v_dot2_f32_bf16 v104, v78, v17, v104
    v_dot2_f32_bf16 v105, v78, v78, v105
    v_dot2_f32_bf16 v106, v78, v38, v106
    v_dot2_f32_bf16 v104, v79, v17, v104
    v_dot2_f32_bf16 v105, v79, v79, v105
    v_dot2_f32_bf16 v106, v79, v39, v106
    s_nop 0
    s_nop 0
    v_add_f32_dpp v104, v104, v104 row_ror:8 row_mask:0xf bank_mask:0xf
    v_add_f32_dpp v105, v105, v105 row_ror:8 row_mask:0xf bank_mask:0xf
    v_add_f32_dpp v106, v106, v106 row_ror:8 row_mask:0xf bank_mask:0xf
    v_add_f32_dpp v104, v104, v104 row_ror:4 row_mask:0xf bank_mask:0xf
    v_add_f32_dpp v105, v105, v105 row_ror:4 row_mask:0xf bank_mask:0xf
    v_add_f32_dpp v106, v106, v106 row_ror:4 row_mask:0xf bank_mask:0xf
    v_add_f32_dpp v104, v104, v104 row_ror:2 row_mask:0xf bank_mask:0xf
    v_add_f32_dpp v105, v105, v105 row_ror:2 row_mask:0xf bank_mask:0xf
    v_add_f32_dpp v106, v106, v106 row_ror:2 row_mask:0xf bank_mask:0xf
    v_add_f32_dpp v104, v104, v104 row_ror:1 row_mask:0xf bank_mask:0xf
    v_add_f32_dpp v105, v105, v105 row_ror:1 row_mask:0xf bank_mask:0xf
    v_add_f32_dpp v106, v106, v106 row_ror:1 row_mask:0xf bank_mask:0xf
    v_mul_f32 v104, 0x3acccccd, v104
    v_mul_f32 v105, 0x3acccccd, v105
    v_fma_f32 v105, -v104, v104, v105
    v_max_f32_e64 v105, 0, v105
    v_cvt_pk_bf16_f32 v104, v104, v104
    v_lshlrev_b32_e64 v104, 16, v104
    v_cvt_pk_bf16_f32 v105, v105, v105
    v_lshlrev_b32_e64 v105, 16, v105
    v_add_f32 v105, 0x3727c5ac, v105
    v_cvt_pk_bf16_f32 v105, v105, v105
    v_lshlrev_b32 v105, 16, v105
    v_sqrt_f32 v105, v105
    v_sub_f32_e64 v112, 0, v104
    v_cvt_pk_bf16_f32 v105, v105, v105
    v_lshlrev_b32 v105, 16, v105
    v_rcp_f32 v113, v105
    v_fma_f32 v106, v112, v18, v106
    v_mul_f32 v106, v106, v113
    v_ashrrev_i32 v107, 31, v106
    v_or_b32 v107, 0x80000000, v107
    v_xor_b32 v106, v106, v107
    v_cmp_ne_u32 vcc, -1, v11
    v_and_b32 v106, 0xfffff800, v106
    v_or_b32 v114, v106, v11
    v_cndmask_b32 v114, 0, v114, vcc
    v_mov_b32 v115, s31
    s_and_b64 vcc, vcc, s[70:71]
    v_lshrrev_b32 v107, 1, v11
    v_lshlrev_b32 v107, 4, v107
    v_cndmask_b32_e64 v107, v15, v107, vcc
    buffer_store_dwordx4 v[112:115], v107, s[20:23], s50 offen sc1
    v_min_u32 v108, v110, v114
    v_max_u32 v110, v110, v114
    v_max_u32 v111, v111, v108
    s_cmp_lt_u32 s30, 3
    s_cbranch_scc0 L_st_done
    s_waitcnt vmcnt(1)
    v_mov_b32 v104, 0
    v_mov_b32 v105, 0
    v_mov_b32_e64 v106, 0
    v_dot2_f32_bf16 v104, v80, v17, v104
    v_dot2_f32_bf16 v105, v80, v80, v105
    v_dot2_f32_bf16 v106, v80, v20, v106
    v_dot2_f32_bf16 v104, v81, v17, v104
    v_dot2_f32_bf16 v105, v81, v81, v105
    v_dot2_f32_bf16 v106, v81, v21, v106
    v_dot2_f32_bf16 v104, v82, v17, v104
    v_dot2_f32_bf16 v105, v82, v82, v105
    v_dot2_f32_bf16 v106, v82, v22, v106
    v_dot2_f32_bf16 v104, v83, v17, v104
    v_dot2_f32_bf16 v105, v83, v83, v105
    v_dot2_f32_bf16 v106, v83, v23, v106
    v_dot2_f32_bf16 v104, v84, v17, v104
    v_dot2_f32_bf16 v105, v84, v84, v105
    v_dot2_f32_bf16 v106, v84, v24, v106
    v_dot2_f32_bf16 v104, v85, v17, v104
    v_dot2_f32_bf16 v105, v85, v85, v105
    v_dot2_f32_bf16 v106, v85, v25, v106
    v_dot2_f32_bf16 v104, v86, v17, v104
    v_dot2_f32_bf16 v105, v86, v86, v105
    v_dot2_f32_bf16 v106, v86, v26, v106
    v_dot2_f32_bf16 v104, v87, v17, v104
    v_dot2_f32_bf16 v105, v87, v87, v105
    v_dot2_f32_bf16 v106, v87, v27, v106
    v_dot2_f32_bf16 v104, v88, v17, v104
    v_dot2_f32_bf16 v105, v88, v88, v105
    v_dot2_f32_bf16 v106, v88, v28, v106
    v_dot2_f32_bf16 v104, v89, v17, v104
    v_dot2_f32_bf16 v105, v89, v89, v105
    v_dot2_f32_bf16 v106, v89, v29, v106
    v_dot2_f32_bf16 v104, v90, v17, v104
    v_dot2_f32_bf16 v105, v90, v90, v105
    v_dot2_f32_bf16 v106, v90, v30, v106
    v_dot2_f32_bf16 v104, v91, v17, v104
    v_dot2_f32_bf16 v105, v91, v91, v105
    v_dot2_f32_bf16 v106, v91, v31, v106
    v_dot2_f32_bf16 v104, v92, v17, v104
    v_dot2_f32_bf16 v105, v92, v92, v105
    v_dot2_f32_bf16 v106, v92, v32, v106
    v_dot2_f32_bf16 v104, v93, v17, v104
    v_dot2_f32_bf16 v105, v93, v93, v105
    v_dot2_f32_bf16 v106, v93, v33, v106
    v_dot2_f32_bf16 v104, v94, v17, v104
    v_dot2_f32_bf16 v105, v94, v94, v105
    v_dot2_f32_bf16 v106, v94, v34, v106
    v_dot2_f32_bf16 v104, v95, v17, v104
    v_dot2_f32_bf16 v105, v95, v95, v105
    v_dot2_f32_bf16 v106, v95, v35, v106
    v_dot2_f32_bf16 v104, v96, v17, v104
    v_dot2_f32_bf16 v105, v96, v96, v105
    v_dot2_f32_bf16 v106, v96, v36, v106
    v_dot2_f32_bf16 v104, v97, v17, v104
    v_dot2_f32_bf16 v105, v97, v97, v105
    v_dot2_f32_bf16 v106, v97, v37, v106
    v_dot2_f32_bf16 v104, v98, v17, v104
    v_dot2_f32_bf16 v105, v98, v98, v105
    v_dot2_f32_bf16 v106, v98, v38, v106
    v_dot2_f32_bf16 v104, v99, v17, v104
    v_dot2_f32_bf16 v105, v99, v99, v105
    v_dot2_f32_bf16 v106, v99, v39, v106
    s_nop 0
    s_nop 0
    v_add_f32_dpp v104, v104, v104 row_ror:8 row_mask:0xf bank_mask:0xf
    v_add_f32_dpp v105, v105, v105 row_ror:8 row_mask:0xf bank_mask:0xf
    v_add_f32_dpp v106, v106, v106 row_ror:8 row_mask:0xf bank_mask:0xf
    v_add_f32_dpp v104, v104, v104 row_ror:4 row_mask:0xf bank_mask:0xf
    v_add_f32_dpp v105, v105, v105 row_ror:4 row_mask:0xf bank_mask:0xf
    v_add_f32_dpp v106, v106, v106 row_ror:4 row_mask:0xf bank_mask:0xf
    v_add_f32_dpp v104, v104, v104 row_ror:2 row_mask:0xf bank_mask:0xf
    v_add_f32_dpp v105, v105, v105 row_ror:2 row_mask:0xf bank_mask:0xf
    v_add_f32_dpp v106, v106, v106 row_ror:2 row_mask:0xf bank_mask:0xf
    v_add_f32_dpp v104, v104, v104 row_ror:1 row_mask:0xf bank_mask:0xf
    v_add_f32_dpp v105, v105, v105 row_ror:1 row_mask:0xf bank_mask:0xf
    v_add_f32_dpp v106, v106, v106 row_ror:1 row_mask:0xf bank_mask:0xf
    v_mul_f32 v104, 0x3acccccd, v104
    v_mul_f32 v105, 0x3acccccd, v105
    v_fma_f32 v105, -v104, v104, v105
    v_max_f32_e64 v105, 0, v105
    v_cvt_pk_bf16_f32 v104, v104, v104
    v_lshlrev_b32_e64 v104, 16, v104
    v_cvt_pk_bf16_f32 v105, v105, v105
    v_lshlrev_b32_e64 v105, 16, v105
    v_add_f32 v105, 0x3727c5ac, v105
    v_cvt_pk_bf16_f32 v105, v105, v105
    v_lshlrev_b32 v105, 16, v105
    v_sqrt_f32 v105, v105
    v_sub_f32_e64 v112, 0, v104
    v_cvt_pk_bf16_f32 v105, v105, v105
    v_lshlrev_b32 v105, 16, v105
    v_rcp_f32 v113, v105
    v_fma_f32 v106, v112, v18, v106
    v_mul_f32 v106, v106, v113
    v_ashrrev_i32 v107, 31, v106
    v_or_b32 v107, 0x80000000, v107
    v_xor_b32 v106, v106, v107
    v_cmp_ne_u32 vcc, -1, v12
    v_and_b32 v106, 0xfffff800, v106
    v_or_b32 v114, v106, v12
    v_cndmask_b32 v114, 0, v114, vcc
    v_mov_b32 v115, s31
    s_and_b64 vcc, vcc, s[70:71]
    v_lshrrev_b32 v107, 1, v12
    v_lshlrev_b32 v107, 4, v107
    v_cndmask_b32_e64 v107, v15, v107, vcc
    buffer_store_dwordx4 v[112:115], v107, s[20:23], s50 offen sc1
    v_min_u32 v108, v110, v114
    v_max_u32 v110, v110, v114
    v_max_u32 v111, v111, v108
L_st_done:
    v_mov_b32 v104, v110
    v_mov_b32 v105, v111
    s_nop 0
    v_permlane16_swap_b32 v104, v110
    v_permlane16_swap_b32 v105, v111
    v_min_u32 v106, v104, v110
    v_max_u32 v110, v104, v110
    v_max3_u32 v111, v111, v105, v106
    v_mov_b32 v104, v110
    v_mov_b32 v105, v111
    s_nop 0
    v_permlane32_swap_b32 v104, v110
    v_permlane32_swap_b32 v105, v111
    v_min_u32 v106, v104, v110
    v_max_u32_e64 v110, v104, v110
    v_max3_u32 v111, v111, v105, v106
    s_lshl_b32 s47, s30, 3
    v_mov_b32 v7, s47
    ds_write_b64 v7, v[110:111]
    s_and_b32 s48, s28, 1
    s_sub_u32 s51, 4, s48
    s_mul_i32 s51, s51, s30
    s_lshr_b32 s47, s33, 1
    s_add_u32 s47, s47, s51
    s_lshl_b32 s47, s47, 6
    v_add_u32 v9, s47, v0
    s_waitcnt lgkmcnt(0)
    s_barrier
    s_cmp_eq_u32 s30, 0
    s_cbranch_scc0 L_st_pf
    v_and_b32 v7, 7, v0
    v_lshlrev_b32_e64 v7, 3, v7
    ds_read_b64 v[116:117], v7
    s_waitcnt lgkmcnt(0)
    v_mov_b32_dpp v104, v116 row_ror:4 row_mask:0xf bank_mask:0xf
    v_mov_b32_dpp v105, v117 row_ror:4 row_mask:0xf bank_mask:0xf
    v_min_u32 v106, v116, v104
    v_max_u32_e64 v116, v116, v104
    v_max3_u32 v117, v117, v105, v106
    s_nop 0
    v_mov_b32_dpp v104, v116 row_ror:2 row_mask:0xf bank_mask:0xf
    v_mov_b32_dpp v105, v117 row_ror:2 row_mask:0xf bank_mask:0xf
    v_min_u32 v106, v116, v104
    v_max_u32_e64 v116, v116, v104
    v_max3_u32 v117, v117, v105, v106
    s_nop 0
    v_mov_b32_dpp v104, v116 row_ror:1 row_mask:0xf bank_mask:0xf
    v_mov_b32_dpp v105, v117 row_ror:1 row_mask:0xf bank_mask:0xf
    v_min_u32 v106, v116, v104
    v_max_u32_e64 v116, v116, v104
    v_max3_u32 v117, v117, v105, v106
    v_mov_b32 v118, v117
    v_mov_b32 v117, s31
    v_mov_b32 v119, s31
    v_lshlrev_b32_e64 v7, 4, v0
    s_mul_i32 s47, s32, 7
    s_add_u32 s47, s47, s33
    s_lshl_b32 s47, s47, 7
    s_add_u32 s47, s47, 45056
    s_mov_b64 exec, 0xff
    buffer_store_dwordx4 v[116:119], v7, s[20:23], s47 offen sc1
    s_add_u32 s47, s47, 12288
    buffer_store_dwordx4 v[116:119], v7, s[20:23], s47 offen sc1
    s_mov_b64 exec, -1
L_st_pf:
    s_barrier
    v_add_u32 v13, 0, v9
    s_movk_i32 s50, 1600
    v_cmp_gt_u32_e64 vcc, s50, v13
    s_mul_i32 s47, s32, 400
    v_add_u32 v13, s47, v13
    v_subrev_u32 v8, s50, v13
    v_min_u32_e64 v13, v13, v8
    v_mul_u32_u24 v8, 13108, v13
    v_lshrrev_b32_e64 v8, 16, v8
    v_mul_u32_u24 v8, 640, v8
    v_lshl_add_u32 v8, v13, 7, v8
    v_cndmask_b32 v8, v15, v8, vcc
    s_xor_b32 s47, s48, 0
    s_mul_i32 s47, s47, 409600
    s_mul_i32 s50, s48, 640
    s_add_u32 s47, s47, s50
    buffer_load_dword v255, v8, s[16:19], s47 offen
    s_cmp_eq_u32 s33, 1
    s_cbranch_scc0 L_pw_13
    s_cmp_eq_u32 s30, 0
    s_cbranch_scc0 L_pw_13
    v_add_u32 v13, 1536, v9
    s_movk_i32 s50, 1600
    v_cmp_gt_u32_e64 vcc, s50, v13
    s_mul_i32 s47, s32, 400
    v_add_u32 v13, s47, v13
    v_subrev_u32 v8, s50, v13
    v_min_u32_e64 v13, v13, v8
    v_mul_u32_u24 v8, 13108, v13
    v_lshrrev_b32_e64 v8, 16, v8
    v_mul_u32_u24 v8, 640, v8
    v_lshl_add_u32 v8, v13, 7, v8
    v_cndmask_b32 v8, v15, v8, vcc
    s_xor_b32 s47, s48, 0
    s_mul_i32 s47, s47, 409600
    s_mul_i32 s50, s48, 640
    s_add_u32 s47, s47, s50
    buffer_load_dword v255, v8, s[16:19], s47 offen
L_pw_13:
    s_barrier
    s_mul_i32 s47, s32, 7
    s_sub_u32 s47, s47, s48
    s_add_u32 s47, s47, 1
    s_mul_i32 s49, s47, 81920
    s_add_u32 s47, s48, 3
    s_mul_i32 s47, s47, 320
    v_mul_u32_u24 v8, 13108, v9
    v_lshrrev_b32 v8, 16, v8
    v_lshrrev_b32 v13, 6, v8
    v_mul_u32_u24 v8, 640, v8
    v_lshl_add_u32 v8, v9, 7, v8
    v_mul_u32_u24 v13, 81920, v13
    v_add_u32 v8, v8, v13
    v_cmp_gt_u32 vcc, s47, v9
    s_nop 1
    v_cndmask_b32 v8, v15, v8, vcc
    buffer_load_dword v255, v8, s[64:67], s49 offen offset:640
    s_barrier
    v_add_u32 v13, 0, v9
    s_movk_i32 s50, 1600
    v_cmp_gt_u32 vcc, s50, v13
    s_mul_i32 s47, s32, 400
    v_add_u32 v13, s47, v13
    v_subrev_u32 v8, s50, v13
    v_min_u32_e64 v13, v13, v8
    v_mul_u32_u24 v8, 13108, v13
    v_lshrrev_b32_e64 v8, 16, v8
    v_mul_u32_u24 v8, 640, v8
    v_lshl_add_u32 v8, v13, 7, v8
    v_cndmask_b32 v8, v15, v8, vcc
    s_xor_b32 s47, s48, 1
    s_mul_i32 s47, s47, 409600
    s_mul_i32 s50, s48, 640
    s_add_u32 s47, s47, s50
    buffer_load_dword v255, v8, s[16:19], s47 offen
    s_cmp_eq_u32 s33, 1
    s_cbranch_scc0 L_pw_14
    s_cmp_eq_u32 s30, 0
    s_cbranch_scc0 L_pw_14
    v_add_u32 v13, 1536, v9
    s_movk_i32 s50, 1600
    v_cmp_gt_u32_e64 vcc, s50, v13
    s_mul_i32 s47, s32, 400
    v_add_u32 v13, s47, v13
    v_subrev_u32 v8, s50, v13
    v_min_u32_e64 v13, v13, v8
    v_mul_u32_u24 v8, 13108, v13
    v_lshrrev_b32_e64 v8, 16, v8
    v_mul_u32_u24 v8, 640, v8
    v_lshl_add_u32 v8, v13, 7, v8
    v_cndmask_b32 v8, v15, v8, vcc
    s_xor_b32 s47, s48, 1
    s_mul_i32 s47, s47, 409600
    s_mul_i32 s50, s48, 640
    s_add_u32 s47, s47, s50
    buffer_load_dword v255, v8, s[16:19], s47 offen
L_pw_14:
    s_endpgm
L_moe:
    s_mul_i32 s34, s32, 7
    s_add_u32 s34, s34, s33
    s_sub_u32 s34, s34, 7
    s_cmp_eq_u32 s34, 27
    s_cbranch_scc1 L_sel
    s_nop 0
    s_load_dwordx2 s[64:65], s[0:1], 40
    s_load_dwordx2 s[68:69], s[0:1], 48
    s_load_dwordx2 s[60:61], s[0:1], 56
    s_mov_b32 s66, 2211840
    s_mov_b32 s67, 0x20000
    s_mov_b32 s70, 2211840
    s_mov_b32 s71, 0x20000
    s_mov_b32 s62, 2211840
    s_mov_b32 s63, 0x20000
    v_lshrrev_b32_e64 v7, 3, v0
    v_mul_u32_u24 v7, 3456, v7
    v_lshl_add_u32 v7, v9, 4, v7
    s_mul_i32 s47, s30, 27648
    s_lshl_b32 s48, s34, 7
    s_add_u32 s48, s47, s48
    s_lshl_b32 s49, s30, 10
    s_waitcnt lgkmcnt(0)
    s_load_dword s31, s[20:21], 0
    s_add_u32 m0, s49, 0
    s_add_u32 s47, s48, 0
    buffer_load_dwordx4 v7, s[64:67], s47 offen nt lds
    s_add_u32 m0, s49, 8192
    s_add_u32 s47, s48, 221184
    buffer_load_dwordx4 v7, s[64:67], s47 offen nt lds
    s_add_u32 m0, s49, 16384
    s_add_u32 s47, s48, 442368
    buffer_load_dwordx4 v7, s[64:67], s47 offen nt lds
    s_add_u32 m0, s49, 24576
    s_add_u32 s47, s48, 663552
    buffer_load_dwordx4 v7, s[64:67], s47 offen nt lds
    s_add_u32 m0, s49, 32768
    s_add_u32 s47, s48, 884736
    buffer_load_dwordx4 v7, s[64:67], s47 offen nt lds
    s_add_u32 m0, s49, 40960
    s_add_u32 s47, s48, 1105920
    buffer_load_dwordx4 v7, s[64:67], s47 offen nt lds
    s_add_u32 m0, s49, 49152
    s_add_u32 s47, s48, 1327104
    buffer_load_dwordx4 v7, s[64:67], s47 offen nt lds
    s_add_u32 m0, s49, 57344
    s_add_u32 s47, s48, 1548288
    buffer_load_dwordx4 v7, s[64:67], s47 offen nt lds
    s_add_u32 m0, s49, 65536
    s_add_u32 s47, s48, 1769472
    buffer_load_dwordx4 v7, s[64:67], s47 offen nt lds
    s_add_u32 m0, s49, 73728
    s_add_u32 s47, s48, 1990656
    buffer_load_dwordx4 v7, s[64:67], s47 offen nt lds
    s_lshr_b32 s35, s30, 2
    s_mul_i32 s50, s34, 81920
    s_mul_i32 s47, s30, 10240
    s_add_u32 s50, s50, s47
    v_bfe_u32 v10, v0, 2, 2
    v_lshl_add_u32 v10, v6, 3, v10
    v_lshlrev_b32 v10, 7, v10
    v_and_b32 v11, 3, v0
    v_lshl_add_u32 v10, v11, 3, v10
    v_bfe_u32 v11, v0, 3, 2
    v_lshlrev_b32 v11, 5, v11
    s_mul_i32 s51, s30, 5
    s_add_u32 s47, s51, 0
    s_and_b32 s52, s47, 3
    s_lshl_b32 s52, s52, 5
    s_lshr_b32 s47, s47, 2
    s_lshl_b32 s47, s47, 13
    s_or_b32 s47, s47, s52
    v_xad_u32 v12, s47, v11, v10
    s_add_u32 s47, s51, 1
    s_and_b32 s52, s47, 3
    s_lshl_b32 s52, s52, 5
    s_lshr_b32 s47, s47, 2
    s_lshl_b32 s47, s47, 13
    s_or_b32 s47, s47, s52
    v_xad_u32 v13, s47, v11, v10
    s_add_u32 s47, s51, 2
    s_and_b32 s52, s47, 3
    s_lshl_b32 s52, s52, 5
    s_lshr_b32 s47, s47, 2
    s_lshl_b32 s47, s47, 13
    s_or_b32 s47, s47, s52
    v_xad_u32 v14, s47, v11, v10
    s_add_u32 s47, s51, 3
    s_and_b32 s52, s47, 3
    s_lshl_b32 s52, s52, 5
    s_lshr_b32 s47, s47, 2
    s_lshl_b32 s47, s47, 13
    s_or_b32 s47, s47, s52
    v_xad_u32 v15, s47, v11, v10
    s_add_u32 s47, s51, 4
    s_and_b32 s52, s47, 3
    s_lshl_b32 s52, s52, 5
    s_lshr_b32 s47, s47, 2
    s_lshl_b32 s47, s47, 13
    s_or_b32 s47, s47, s52
    v_xad_u32 v16, s47, v11, v10
    s_and_b32 s52, s30, 3
    s_lshl_b32 s47, s52, 5
    v_xad_u32 v17, s47, v11, v10
    s_mul_i32 s47, s35, 40960
    v_add_u32_e64 v17, s47, v17
    v_add_u32 v18, 81920, v17
    v_cmp_eq_u32_e64 vcc, 2, v5
    v_mov_b32 v19, 0x3f803f80
    s_nop 0
    v_cndmask_b32 v19, 0, v19, vcc
    v_mov_b32 v100, v19
    v_mov_b32 v101, v19
    v_mov_b32 v102, v19
    v_mov_b32 v103, v19
    v_mov_b32 v104, v19
    v_mov_b32 v105, v19
    v_mov_b32 v106, v19
    v_mov_b32 v107, v19
    v_mov_b32 v108, v19
    v_mov_b32 v109, v19
    v_mov_b32 v110, v19
    v_mov_b32 v111, v19
    v_mov_b32 v112, v19
    v_mov_b32 v113, v19
    v_mov_b32 v114, v19
    v_mov_b32 v115, v19
    v_mov_b32 v116, v19
    v_mov_b32 v117, v19
    v_mov_b32 v118, v19
    v_mov_b32 v119, v19
    v_mov_b32 v120, v19
    v_mov_b32 v121, v19
    v_mov_b32 v122, v19
    v_mov_b32 v123, v19
    v_mov_b32 v124, v19
    v_mov_b32 v125, v19
    v_mov_b32 v126, v19
    v_mov_b32 v127, v19
    v_mov_b32 v128, v19
    v_mov_b32 v129, v19
    v_mov_b32 v130, v19
    v_mov_b32 v131, v19
    v_mov_b32 v132, v19
    v_mov_b32 v133, v19
    v_mov_b32 v134, v19
    v_mov_b32 v135, v19
    v_mov_b32 v136, v19
    v_mov_b32 v137, v19
    v_mov_b32 v138, v19
    v_mov_b32 v139, v19
    v_cmp_gt_u32 s[72:73], 2, v5
    s_barrier
    s_add_u32 m0, s49, 81920
    s_add_u32 s47, s48, 0
    buffer_load_dwordx4 v7, s[68:71], s47 offen nt lds
    s_add_u32 m0, s49, 90112
    s_add_u32 s47, s48, 221184
    buffer_load_dwordx4 v7, s[68:71], s47 offen nt lds
    s_add_u32 m0, s49, 98304
    s_add_u32 s47, s48, 442368
    buffer_load_dwordx4 v7, s[68:71], s47 offen nt lds
    s_add_u32 m0, s49, 106496
    s_add_u32 s47, s48, 663552
    buffer_load_dwordx4 v7, s[68:71], s47 offen nt lds
    s_add_u32 m0, s49, 114688
    s_add_u32 s47, s48, 884736
    buffer_load_dwordx4 v7, s[68:71], s47 offen nt lds
    s_add_u32 m0, s49, 122880
    s_add_u32 s47, s48, 1105920
    buffer_load_dwordx4 v7, s[68:71], s47 offen nt lds
    s_add_u32 m0, s49, 131072
    s_add_u32 s47, s48, 1327104
    buffer_load_dwordx4 v7, s[68:71], s47 offen nt lds
    s_add_u32 m0, s49, 139264
    s_add_u32 s47, s48, 1548288
    buffer_load_dwordx4 v7, s[68:71], s47 offen nt lds
    s_add_u32 m0, s49, 147456
    s_add_u32 s47, s48, 1769472
    buffer_load_dwordx4 v7, s[68:71], s47 offen nt lds
    s_add_u32 m0, s49, 155648
    s_add_u32 s47, s48, 1990656
    buffer_load_dwordx4 v7, s[68:71], s47 offen nt lds
    s_waitcnt vmcnt(10) lgkmcnt(0)
    s_barrier
    ds_read_b64_tr_b16 v[20:21], v17 offset:0
    ds_read_b64_tr_b16 v[22:23], v17 offset:512
    ds_read_b64_tr_b16 v[24:25], v17 offset:4096
    ds_read_b64_tr_b16 v[26:27], v17 offset:4608
    ds_read_b64_tr_b16 v[28:29], v17 offset:8192
    ds_read_b64_tr_b16 v[30:31], v17 offset:8704
    ds_read_b64_tr_b16 v[32:33], v17 offset:12288
    ds_read_b64_tr_b16 v[34:35], v17 offset:12800
    ds_read_b64_tr_b16 v[36:37], v17 offset:16384
    ds_read_b64_tr_b16 v[38:39], v17 offset:16896
    ds_read_b64_tr_b16 v[40:41], v17 offset:20480
    ds_read_b64_tr_b16 v[42:43], v17 offset:20992
    ds_read_b64_tr_b16 v[44:45], v17 offset:24576
    ds_read_b64_tr_b16 v[46:47], v17 offset:25088
    ds_read_b64_tr_b16 v[48:49], v17 offset:28672
    ds_read_b64_tr_b16 v[50:51], v17 offset:29184
    ds_read_b64_tr_b16 v[52:53], v17 offset:32768
    ds_read_b64_tr_b16 v[54:55], v17 offset:33280
    ds_read_b64_tr_b16 v[56:57], v17 offset:36864
    ds_read_b64_tr_b16 v[58:59], v17 offset:37376
    s_add_u32 s31, s31, 117768961
    s_bfe_u32 s74, s31, 524288
    s_bfe_u32 s75, s31, 524296
    s_bfe_u32 s76, s31, 524304
    s_bfe_u32 s77, s31, 524312
    s_waitcnt lgkmcnt(0)
    s_barrier
    s_add_u32 m0, s49, 0
    s_add_u32 s47, s50, 0
    buffer_load_dwordx4 v4, s[60:63], s47 offen nt lds
    s_add_u32 m0, s49, 8192
    s_add_u32 s47, s50, 128
    buffer_load_dwordx4 v4, s[60:63], s47 offen nt lds
    s_add_u32 m0, s49, 16384
    s_add_u32 s47, s50, 256
    buffer_load_dwordx4 v4, s[60:63], s47 offen nt lds
    s_waitcnt vmcnt(3)
    s_barrier
    ds_read_b64_tr_b16 v[60:61], v18 offset:0
    ds_read_b64_tr_b16 v[62:63], v18 offset:512
    ds_read_b64_tr_b16 v[64:65], v18 offset:4096
    ds_read_b64_tr_b16 v[66:67], v18 offset:4608
    ds_read_b64_tr_b16 v[68:69], v18 offset:8192
    ds_read_b64_tr_b16 v[70:71], v18 offset:8704
    ds_read_b64_tr_b16 v[72:73], v18 offset:12288
    ds_read_b64_tr_b16 v[74:75], v18 offset:12800
    ds_read_b64_tr_b16 v[76:77], v18 offset:16384
    ds_read_b64_tr_b16 v[78:79], v18 offset:16896
    ds_read_b64_tr_b16 v[80:81], v18 offset:20480
    ds_read_b64_tr_b16 v[82:83], v18 offset:20992
    ds_read_b64_tr_b16 v[84:85], v18 offset:24576
    ds_read_b64_tr_b16 v[86:87], v18 offset:25088
    ds_read_b64_tr_b16 v[88:89], v18 offset:28672
    ds_read_b64_tr_b16 v[90:91], v18 offset:29184
    ds_read_b64_tr_b16 v[92:93], v18 offset:32768
    ds_read_b64_tr_b16 v[94:95], v18 offset:33280
    ds_read_b64_tr_b16 v[96:97], v18 offset:36864
    ds_read_b64_tr_b16 v[98:99], v18 offset:37376
    s_lshl_b32 s47, s52, 8
    s_add_u32 s47, s47, 81920
    v_lshl_add_u32 v8, v5, 4, s47
    s_lshl_b32 s47, s52, 5
    s_add_u32 s47, s47, 82944
    v_lshl_add_u32 v10, v5, 1, s47
    v_and_b32 v7, 1, v5
    v_lshlrev_b32 v9, 7, v7
    v_lshl_add_u32 v9, v6, 4, v9
    v_add_u32 v9, 82944, v9
    s_mul_i32 s47, s35, 640
    s_add_u32 s47, s47, 83968
    v_mul_u32_u24 v11, 1280, v7
    v_lshl_add_u32 v11, v6, 4, v11
    v_add_u32_e64 v11, s47, v11
    v_mov_b32 v17, 87040
    s_waitcnt lgkmcnt(0)
    s_barrier
    s_add_u32 m0, s49, 24576
    s_add_u32 s47, s50, 384
    buffer_load_dwordx4 v4, s[60:63], s47 offen nt lds
    s_add_u32 m0, s49, 32768
    s_add_u32 s47, s50, 512
    buffer_load_dwordx4 v4, s[60:63], s47 offen nt lds
    s_cmp_eq_u32 s30, 0
    s_cbranch_scc0 L_mh_skip
    s_lshl_b32 s47, s34, 7
    s_add_u32 s47, s47, 53248
    s_mov_b32 s46, 262144
L_mh:
    s_load_dwordx4 s[36:39], s[20:21], s47 glc
    s_waitcnt lgkmcnt(0)
    s_cmp_lg_u32 s38, s31
    s_cbranch_scc0 L_mh_ok
    s_sub_u32 s46, s46, 1
    s_cmp_lg_u32 s46, 0
    s_cbranch_scc1 L_mh
L_mh_ok:
    s_and_b32 s36, s36, 0x7ff
    s_and_b32 s37, s37, 0x7ff
    s_mul_i32 s38, s36, 1280
    s_mul_i32 s39, s37, 1280
    v_lshlrev_b32 v18, 4, v0
    s_mov_b32 m0, 83968
    v_cmp_gt_u32_e64 vcc, 16, v0
    buffer_load_dwordx4 v18, s[8:11], s38 offen lds
    s_add_u32 s38, s38, 1024
    s_sub_u32 s47, s39, 256
    v_mov_b32 v19, s38
    v_mov_b32 v3, s47
    v_cndmask_b32_e64 v19, v3, v19, vcc
    s_mov_b32 m0, 84992
    v_add_u32_e64 v19, v19, v18
    buffer_load_dwordx4 v19, s[8:11], 0 offen lds
    s_mov_b32 m0, 86016
    s_add_u32 s39, s39, 768
    s_mov_b32 exec_hi, 0
    buffer_load_dwordx4 v18, s[8:11], s39 offen lds
    s_mov_b32 exec_hi, -1
    v_mov_b32 v2, s36
    v_mov_b32 v3, s37
    v_cmp_eq_u32 vcc, 0, v7
    s_movk_i32 s48, 8192
    s_nop 0
    v_cndmask_b32 v2, v3, v2, vcc
    v_and_b32 v3, 1, v2
    v_lshlrev_b32 v3, 14, v3
    v_lshrrev_b32_e64 v2, 1, v2
    v_lshl_add_u32 v3, v2, 4, v3
    buffer_load_dwordx4 v[152:155], v3, s[20:23], s48 offen sc1
    s_barrier
    s_nop 0
    s_add_u32 m0, s49, 40960
    s_add_u32 s47, s50, 640
    buffer_load_dwordx4 v4, s[60:63], s47 offen nt lds
    s_add_u32 m0, s49, 49152
    s_add_u32 s47, s50, 768
    buffer_load_dwordx4 v4, s[60:63], s47 offen nt lds
    s_add_u32 m0, s49, 57344
    s_add_u32 s47, s50, 896
    buffer_load_dwordx4 v4, s[60:63], s47 offen nt lds
    s_add_u32 m0, s49, 65536
    s_add_u32 s47, s50, 1024
    buffer_load_dwordx4 v4, s[60:63], s47 offen nt lds
    s_add_u32 m0, s49, 73728
    s_add_u32 s47, s50, 1152
    buffer_load_dwordx4 v4, s[60:63], s47 offen nt lds
    s_waitcnt vmcnt(5)
    v_cmp_ne_u32 vcc, s31, v155
    s_cmp_lg_u64 vcc, 0
    s_cbranch_scc0 L_ms_ok
    s_mov_b32 s46, 262144
L_ms:
    buffer_load_dwordx4 v[152:155], v3, s[20:23], s48 offen sc1
    s_waitcnt vmcnt(0)
    v_cmp_ne_u32 vcc, s31, v155
    s_cmp_lg_u64 vcc, 0
    s_cbranch_scc0 L_ms_ok
    s_sleep 1
    s_sub_u32 s46, s46, 1
    s_cmp_lg_u32 s46, 0
    s_cbranch_scc1 L_ms
L_ms_ok:
    v_lshl_add_u32 v2, v7, 3, v17
    ds_write_b64 v2, v[152:153]
    s_waitcnt lgkmcnt(0)
    s_branch L_mh_join
L_mh_skip:
    s_barrier
    s_nop 0
    s_add_u32 m0, s49, 40960
    s_add_u32 s47, s50, 640
    buffer_load_dwordx4 v4, s[60:63], s47 offen nt lds
    s_add_u32 m0, s49, 49152
    s_add_u32 s47, s50, 768
    buffer_load_dwordx4 v4, s[60:63], s47 offen nt lds
    s_add_u32 m0, s49, 57344
    s_add_u32 s47, s50, 896
    buffer_load_dwordx4 v4, s[60:63], s47 offen nt lds
    s_add_u32 m0, s49, 65536
    s_add_u32 s47, s50, 1024
    buffer_load_dwordx4 v4, s[60:63], s47 offen nt lds
    s_add_u32 m0, s49, 73728
    s_add_u32 s47, s50, 1152
    buffer_load_dwordx4 v4, s[60:63], s47 offen nt lds
L_mh_join:
    s_barrier
    ds_read_b128 v[152:155], v17
    s_mov_b64 exec, s[72:73]
    ds_read_b128 v[100:103], v11 offset:0
    ds_read_b128 v[104:107], v11 offset:64
    ds_read_b128 v[108:111], v11 offset:128
    ds_read_b128 v[112:115], v11 offset:192
    ds_read_b128 v[116:119], v11 offset:256
    ds_read_b128 v[120:123], v11 offset:320
    ds_read_b128 v[124:127], v11 offset:384
    ds_read_b128 v[128:131], v11 offset:448
    ds_read_b128 v[132:135], v11 offset:512
    ds_read_b128 v[136:139], v11 offset:576
    s_mov_b64 exec, -1
    s_waitcnt lgkmcnt(0)
    v_mfma_f32_16x16x32_bf16 v[140:143], v[100:103], v[20:23], 0
    v_mfma_f32_16x16x32_bf16 v[144:147], v[100:103], v[60:63], 0
    v_mfma_f32_16x16x32_bf16 v[140:143], v[104:107], v[24:27], v[140:143]
    v_mfma_f32_16x16x32_bf16 v[144:147], v[104:107], v[64:67], v[144:147]
    v_mfma_f32_16x16x32_bf16 v[140:143], v[108:111], v[28:31], v[140:143]
    v_mfma_f32_16x16x32_bf16 v[144:147], v[108:111], v[68:71], v[144:147]
    v_mfma_f32_16x16x32_bf16 v[140:143], v[112:115], v[32:35], v[140:143]
    v_mfma_f32_16x16x32_bf16 v[144:147], v[112:115], v[72:75], v[144:147]
    v_mfma_f32_16x16x32_bf16 v[140:143], v[116:119], v[36:39], v[140:143]
    v_mfma_f32_16x16x32_bf16 v[144:147], v[116:119], v[76:79], v[144:147]
    v_mfma_f32_16x16x32_bf16 v[140:143], v[120:123], v[40:43], v[140:143]
    v_mfma_f32_16x16x32_bf16 v[144:147], v[120:123], v[80:83], v[144:147]
    v_mfma_f32_16x16x32_bf16 v[140:143], v[124:127], v[44:47], v[140:143]
    v_mfma_f32_16x16x32_bf16 v[144:147], v[124:127], v[84:87], v[144:147]
    v_mfma_f32_16x16x32_bf16 v[140:143], v[128:131], v[48:51], v[140:143]
    v_mfma_f32_16x16x32_bf16 v[144:147], v[128:131], v[88:91], v[144:147]
    v_mfma_f32_16x16x32_bf16 v[140:143], v[132:135], v[52:55], v[140:143]
    v_mfma_f32_16x16x32_bf16 v[144:147], v[132:135], v[92:95], v[144:147]
    v_mfma_f32_16x16x32_bf16 v[140:143], v[136:139], v[56:59], v[140:143]
    v_mfma_f32_16x16x32_bf16 v[144:147], v[136:139], v[96:99], v[144:147]
    s_nop 6
    v_fma_f32 v148, v152, v142, v140
    v_mul_f32 v148, v153, v148
    v_fma_f32 v149, v154, v142, v141
    v_mul_f32_e64 v149, v155, v149
    v_fma_f32 v150, v152, v146, v144
    v_mul_f32_e64 v150, v153, v150
    v_fma_f32 v151, v154, v146, v145
    v_mul_f32_e64 v151, v155, v151
    s_mov_b64 exec, 0xffff
    s_cmp_eq_u32 s35, 0
    s_cbranch_scc1 L_mlo
    ds_write_b128 v8, v[148:151]
L_mlo:
    s_mov_b64 exec, -1
    s_waitcnt vmcnt(0) lgkmcnt(0)
    s_barrier
    s_nop 0
    ds_read_b128 v[152:155], v8
    ds_read_b64_tr_b16 v[160:161], v12 offset:0
    ds_read_b64_tr_b16 v[162:163], v12 offset:512
    ds_read_b64_tr_b16 v[164:165], v12 offset:4096
    ds_read_b64_tr_b16 v[166:167], v12 offset:4608
    ds_read_b64_tr_b16 v[168:169], v13 offset:0
    ds_read_b64_tr_b16 v[170:171], v13 offset:512
    ds_read_b64_tr_b16 v[172:173], v13 offset:4096
    ds_read_b64_tr_b16 v[174:175], v13 offset:4608
    ds_read_b64_tr_b16 v[176:177], v14 offset:0
    ds_read_b64_tr_b16 v[178:179], v14 offset:512
    ds_read_b64_tr_b16 v[180:181], v14 offset:4096
    ds_read_b64_tr_b16 v[182:183], v14 offset:4608
    ds_read_b64_tr_b16 v[184:185], v15 offset:0
    ds_read_b64_tr_b16 v[186:187], v15 offset:512
    ds_read_b64_tr_b16 v[188:189], v15 offset:4096
    ds_read_b64_tr_b16 v[190:191], v15 offset:4608
    ds_read_b64_tr_b16 v[192:193], v16 offset:0
    ds_read_b64_tr_b16 v[194:195], v16 offset:512
    ds_read_b64_tr_b16 v[196:197], v16 offset:4096
    ds_read_b64_tr_b16 v[198:199], v16 offset:4608
    s_cmp_eq_u32 s35, 0
    s_cbranch_scc0 L_noh
    s_waitcnt lgkmcnt(14)
    v_add_f32 v148, v148, v152
    v_add_f32 v149, v149, v153
    v_add_f32 v150, v150, v154
    v_add_f32_e64 v151, v151, v155
    v_mul_f32 v140, 0xbfb8aa3b, v148
    v_mul_f32 v141, 0xbfb8aa3b, v149
    v_exp_f32 v140, v140
    v_exp_f32 v141, v141
    v_add_f32 v140, 1.0, v140
    v_add_f32 v141, 1.0, v141
    v_rcp_f32 v140, v140
    v_rcp_f32 v141, v141
    v_mul_f32 v148, v148, v150
    v_mul_f32 v149, v149, v151
    v_mul_f32 v140, v140, v148
    v_mul_f32 v141, v141, v149
    v_cvt_pk_bf16_f32 v140, v140, v141
    s_mov_b64 exec, 0xffff
    ds_write_b16 v10, v140
    ds_write_b16_d16_hi v10, v140 offset:128
    s_mov_b64 exec, -1
L_noh:
    v_lshrrev_b32 v2, 1, v5
    v_mul_u32_u24 v8, 320, v7
    v_lshl_add_u32 v8, v2, 6, v8
    v_lshl_add_u32 v8, v6, 4, v8
    v_cmp_gt_u32_e64 vcc, 5, v2
    v_mov_b32 v10, 2130706432
    v_cmp_eq_u32 s[36:37], 1, v2
    v_cmp_eq_u32 s[38:39], 2, v2
    v_cmp_eq_u32 s[40:41], 3, v2
    v_cmp_eq_u32 s[42:43], 4, v2
    v_cndmask_b32_e64 v8, v10, v8, vcc
    s_mul_i32 s47, s34, 5120
    s_mul_i32 s48, s30, 640
    s_add_u32 s47, s47, s48
    s_add_u32 s47, s47, 65536
    v_mov_b32 v11, 0xffffff00
    s_waitcnt lgkmcnt(0)
    s_barrier
    ds_read_b128 v[20:23], v9 offset:0
    ds_read_b128 v[24:27], v9 offset:64
    s_waitcnt lgkmcnt(0)
    v_mfma_f32_16x16x32_bf16 v[80:83], v[160:163], v[20:23], 0
    v_mfma_f32_16x16x32_bf16 v[84:87], v[168:171], v[20:23], 0
    v_mfma_f32_16x16x32_bf16 v[88:91], v[176:179], v[20:23], 0
    v_mfma_f32_16x16x32_bf16 v[92:95], v[184:187], v[20:23], 0
    v_mfma_f32_16x16x32_bf16 v[96:99], v[192:195], v[20:23], 0
    v_mfma_f32_16x16x32_bf16 v[80:83], v[164:167], v[24:27], v[80:83]
    v_mfma_f32_16x16x32_bf16 v[84:87], v[172:175], v[24:27], v[84:87]
    v_mfma_f32_16x16x32_bf16 v[88:91], v[180:183], v[24:27], v[88:91]
    v_mfma_f32_16x16x32_bf16 v[92:95], v[188:191], v[24:27], v[92:95]
    v_mfma_f32_16x16x32_bf16 v[96:99], v[196:199], v[24:27], v[96:99]
    s_nop 4
    s_nop 0
    v_cndmask_b32 v80, v80, v84, s[36:37]
    v_cndmask_b32 v81, v81, v85, s[36:37]
    v_cndmask_b32 v82, v82, v86, s[36:37]
    v_cndmask_b32 v83, v83, v87, s[36:37]
    v_cndmask_b32 v80, v80, v88, s[38:39]
    v_cndmask_b32 v81, v81, v89, s[38:39]
    v_cndmask_b32 v82, v82, v90, s[38:39]
    v_cndmask_b32 v83, v83, v91, s[38:39]
    v_cndmask_b32 v80, v80, v92, s[40:41]
    v_cndmask_b32 v81, v81, v93, s[40:41]
    v_cndmask_b32 v82, v82, v94, s[40:41]
    v_cndmask_b32 v83, v83, v95, s[40:41]
    v_cndmask_b32 v80, v80, v96, s[42:43]
    v_cndmask_b32 v81, v81, v97, s[42:43]
    v_cndmask_b32 v82, v82, v98, s[42:43]
    v_cndmask_b32 v83, v83, v99, s[42:43]
    v_and_or_b32 v80, v80, v11, s74
    v_and_or_b32 v81, v81, v11, s75
    v_and_or_b32 v82, v82, v11, s76
    v_and_or_b32 v83, v83, v11, s77
    buffer_store_dwordx4 v[80:83], v8, s[20:23], s47 offen sc1
    s_cmp_eq_u32 s30, 7
    s_cbranch_scc0 L_fin
    v_mov_b32 v12, s31
    v_lshlrev_b32_e64 v13, 2, v0
    s_lshl_b32 s48, s34, 7
    s_add_u32 s48, s48, 49152
    s_mov_b32 exec_hi, 0
    buffer_store_dword v12, v13, s[20:23], s48 offen sc1
    s_mov_b32 exec_hi, -1
    s_endpgm
L_sel:
    s_cmp_eq_u32 s30, 0
    s_cbranch_scc0 L_fin
    s_waitcnt lgkmcnt(0)
    s_load_dword s31, s[20:21], 0
    v_min_u32 v7, 26, v0
    v_lshlrev_b32 v7, 7, v7
    s_mov_b32 s48, 49152
    s_waitcnt lgkmcnt(0)
    s_add_u32 s31, s31, 117768961
    v_lshrrev_b32 v19, 1, v0
    v_lshlrev_b32 v19, 7, v19
    v_and_b32 v18, 1, v0
    v_lshl_add_u32 v19, v18, 3, v19
    s_mov_b32 s47, 45056
    v_mov_b32_e64 v12, 0
    s_mov_b32 exec_hi, 0x00ffffff
    s_mov_b32 s46, 262144
L_sc:
    v_mov_b32 v12, 0
    v_mov_b32 v13, 0
    buffer_atomic_add_x2 v[12:13], v19, s[20:23], s47 offen sc0 sc1
    s_waitcnt vmcnt(0)
    v_cmp_ne_u32 vcc, s31, v13
    s_cmp_lg_u64 vcc, 0
    s_cbranch_scc0 L_sc_ok
    s_sub_u32 s46, s46, 1
    s_cmp_lg_u32 s46, 0
    s_cbranch_scc1 L_sc
L_sc_ok:
    s_mov_b32 exec_hi, -1
    v_mov_b32_e64 v13, 0
    v_mov_b32_dpp v16, v12 row_ror:8 row_mask:0xf bank_mask:0xf
    s_nop 0
    v_mov_b32_dpp v17, v13 row_ror:8 row_mask:0xf bank_mask:0xf
    v_min_u32 v18, v12, v16
    v_max_u32_e64 v12, v12, v16
    v_max3_u32 v13, v13, v17, v18
    s_nop 0
    v_mov_b32_dpp v16, v12 row_ror:4 row_mask:0xf bank_mask:0xf
    v_mov_b32_dpp v17, v13 row_ror:4 row_mask:0xf bank_mask:0xf
    v_min_u32 v18, v12, v16
    v_max_u32_e64 v12, v12, v16
    v_max3_u32 v13, v13, v17, v18
    s_nop 0
    v_mov_b32_dpp v16, v12 row_ror:2 row_mask:0xf bank_mask:0xf
    v_mov_b32_dpp v17, v13 row_ror:2 row_mask:0xf bank_mask:0xf
    v_min_u32 v18, v12, v16
    v_max_u32_e64 v12, v12, v16
    v_max3_u32 v13, v13, v17, v18
    s_nop 0
    v_mov_b32_dpp v16, v12 row_ror:1 row_mask:0xf bank_mask:0xf
    v_mov_b32_dpp v17, v13 row_ror:1 row_mask:0xf bank_mask:0xf
    v_min_u32 v18, v12, v16
    v_max_u32_e64 v12, v12, v16
    v_max3_u32 v13, v13, v17, v18
    v_mov_b32 v16, v12
    v_mov_b32 v17, v13
    s_nop 0
    v_permlane16_swap_b32 v16, v12
    v_permlane16_swap_b32 v17, v13
    v_min_u32 v18, v16, v12
    v_max_u32_e64 v12, v16, v12
    v_max3_u32 v13, v13, v17, v18
    v_mov_b32 v16, v12
    v_mov_b32 v17, v13
    s_nop 0
    v_permlane32_swap_b32 v16, v12
    v_permlane32_swap_b32 v17, v13
    v_min_u32 v18, v16, v12
    v_max_u32_e64 v12, v16, v12
    v_max3_u32 v13, v13, v17, v18
    v_mov_b32 v14, s31
    v_mov_b32 v15, s31
    v_lshlrev_b32_e64 v19, 4, v0
    s_mov_b32 s47, 53248
    buffer_store_dwordx4 v[12:15], v19, s[20:23], s47 offen offset:0 sc1
    buffer_store_dwordx4 v[12:15], v19, s[20:23], s47 offen offset:1024 sc1
    buffer_store_dwordx4 v[12:15], v19, s[20:23], s47 offen offset:2048 sc1
    buffer_store_dwordx4 v[12:15], v19, s[20:23], s47 offen offset:3072 sc1
    s_mov_b32 exec_lo, 134217727
    s_mov_b32 exec_hi, 0
    s_mov_b32 s46, 262144
L_sa:
    v_mov_b32 v20, 0
    buffer_atomic_add v20, v7, s[20:23], s48 offen sc0 sc1
    s_waitcnt vmcnt(0)
    v_cmp_ne_u32_e64 vcc, s31, v20
    s_cmp_lg_u64 vcc, 0
    s_cbranch_scc0 L_sa_ok
    s_sleep 8
    s_sub_u32 s46, s46, 1
    s_cmp_lg_u32 s46, 0
    s_cbranch_scc1 L_sa
L_sa_ok:
    s_mov_b64 exec, -1
    s_mov_b32 s48, 229376
    v_add_u32_e64 v8, 0, v0
    v_min_u32 v8, 199, v8
    v_lshlrev_b32 v8, 7, v8
    v_add_u32 v9, 64, v0
    v_min_u32 v9, 199, v9
    v_lshlrev_b32_e64 v9, 7, v9
    v_add_u32 v10, 128, v0
    v_min_u32 v10, 199, v10
    v_lshlrev_b32_e64 v10, 7, v10
    v_add_u32 v11, 192, v0
    v_min_u32 v11, 199, v11
    v_lshlrev_b32_e64 v11, 7, v11
    s_mov_b32 s46, 262144
L_sb:
    buffer_load_dword v20, v8, s[20:23], s48 offen offset:12 sc1
    buffer_load_dword v21, v9, s[20:23], s48 offen offset:12 sc1
    buffer_load_dword v22, v10, s[20:23], s48 offen offset:12 sc1
    buffer_load_dword v23, v11, s[20:23], s48 offen offset:12 sc1
    s_waitcnt vmcnt(0)
    s_mov_b64 s[70:71], 0
    v_cmp_ne_u32 vcc, s31, v20
    s_or_b64 s[70:71], s[70:71], vcc
    v_cmp_ne_u32 vcc, s31, v21
    s_or_b64 s[70:71], s[70:71], vcc
    v_cmp_ne_u32 vcc, s31, v22
    s_or_b64 s[70:71], s[70:71], vcc
    v_cmp_ne_u32 vcc, s31, v23
    s_or_b64 s[70:71], s[70:71], vcc
    s_cbranch_scc0 L_sb_ok
    s_sleep 8
    s_sub_u32 s46, s46, 1
    s_cmp_lg_u32 s46, 0
    s_cbranch_scc1 L_sb
L_sb_ok:
    v_mov_b32 v9, 0
    v_mov_b32 v22, s31
    s_mov_b64 exec, 1
    buffer_store_dword v22, v9, s[20:23], 0 offen offset:0
    s_mov_b64 exec, -1
L_fin:
L_end:
    s_endpgm
L_code_end:
.section .rodata,"a"
.p2align 6
.amdhsa_kernel parallel_sum__sliding_local_dilated__moe_arch_mod__prompt_kernel
  .amdhsa_next_free_vgpr 256
  .amdhsa_next_free_sgpr 102
  .amdhsa_accum_offset 256
  .amdhsa_group_segment_fixed_size 0
  .amdhsa_kernarg_size 88
  .amdhsa_user_sgpr_count 2
  .amdhsa_user_sgpr_kernarg_segment_ptr 1
  .amdhsa_system_sgpr_workgroup_id_x 1
  .amdhsa_float_denorm_mode_32 3
.end_amdhsa_kernel
```
